```python
import torch

def _softmax(x, axis=-1):
    return torch.softmax(x, dim=axis)
def _gelu(x):
    return torch.nn.functional.gelu(x, approximate="tanh")
def _silu(x):
    return torch.nn.functional.silu(x)
def _sigmoid(x):
    return torch.sigmoid(x)
def _layernorm(x, axis=-1, eps=1e-5):
    m = x.mean(dim=axis, keepdim=True)
    v = x.var(dim=axis, keepdim=True, unbiased=False)
    return (x - m) / torch.sqrt(v + eps)
def _scatter_add(tgt, idx, src, axis=0):
    return tgt.clone().index_add_(axis, idx, src)
def _segment_sum(src, seg, n):
    out = torch.zeros((n,) + src.shape[1:], dtype=src.dtype)
    return out.index_add_(0, seg, src)
def _pad(x, pw):
    flat = tuple(v for pair in reversed(pw) for v in pair)
    return torch.nn.functional.pad(x, flat)

kernel_name = 'concat_heads__mha_block__linear_kernel_hedgehog__prompt'

def setup_inputs():

    _w = (lambda a: (lambda t: t.to(torch.bfloat16) if t.is_floating_point() else t)(torch.as_tensor(a)))
    def _A_setup():
        B, S, D, H = 1, 2048, 640, 32
        return {
            "x": _w((lambda *s: torch.randn(*s, dtype=torch.bfloat16) * 0.2)(B, S, D)),
            "wqkv": _w((lambda *s: torch.randn(*s, dtype=torch.bfloat16) * 0.2)(D, 3 * D)),
            "wo": _w((lambda *s: torch.randn(*s, dtype=torch.bfloat16) * 0.05)(D, D)),
        }
    _A_in = _A_setup()

    def _B_setup():
        B, S, D, H = 1, 2048, 640, 32
        Dh = D // H
        return {
            "x": _w((lambda *s: torch.randn(*s, dtype=torch.bfloat16) * 0.4)(B, S, D)),
            "wqkv": _w((lambda *s: torch.randn(*s, dtype=torch.bfloat16) * 0.4)(D, 3 * D)),
            "w_phi": _w((lambda *s: torch.randn(*s, dtype=torch.bfloat16) * 0.4)(H, Dh, Dh) * (Dh ** -0.5)),
            "wo": _w((lambda *s: torch.randn(*s, dtype=torch.bfloat16) * 0.05)(D, D)),
        }
    _B_in = _B_setup()

    return {
        "A_x": _A_in["x"],
        "A_wqkv": _A_in["wqkv"],
        "A_wo": _A_in["wo"],
        "B_x": _B_in["x"],
        "B_wqkv": _B_in["wqkv"],
        "B_w_phi": _B_in["w_phi"],
        "B_wo": _B_in["wo"],
    }

def reference(A_x, A_wqkv, A_wo, B_x, B_wqkv, B_w_phi, B_wo):
    def _A_ref(x, wqkv, wo):
        B, S, D = x.shape
        H = 32
        Dh = D // H
        qkv = (lambda x, *d: x.permute(*d))((x @ wqkv).reshape(B, S, 3, H, Dh), 2, 0, 3, 1, 4)
        q, k, v = qkv[0], qkv[1], qkv[2]
        scores = torch.einsum("bhqd,bhkd->bhqk", q, k) * (Dh ** -0.5)
        p = _softmax(scores, axis=-1)
        o = torch.einsum("bhqk,bhkd->bhqd", p, v)
        return (lambda x, *d: x.permute(*d))(o, 0, 2, 1, 3).reshape(B, S, D) @ wo

    def _B_ref(x, wqkv, w_phi, wo):
        B, S, D = x.shape
        H = 32; Dh = D // H
        qkv = (lambda x, *d: x.permute(*d))((x @ wqkv).reshape(B, S, 3, H, Dh), 2, 0, 3, 1, 4)
        q, k, v = qkv[0], qkv[1], qkv[2]
        pq = torch.einsum("bhsd,hdf->bhsf", q, w_phi)
        pk = torch.einsum("bhsd,hdf->bhsf", k, w_phi)
        phi_q = torch.concatenate([_softmax(pq, axis=-1), _softmax(-pq, axis=-1)], axis=-1)
        phi_k = torch.concatenate([_softmax(pk, axis=-1), _softmax(-pk, axis=-1)], axis=-1)
        kv = torch.einsum("bhsf,bhsd->bhfd", phi_k, v)
        z  = torch.einsum("bhsf->bhf", phi_k)
        num = torch.einsum("bhqf,bhfd->bhqd", phi_q, kv)
        den = torch.einsum("bhqf,bhf->bhq", phi_q, z)[..., None] + 1e-6
        o = num / den
        return (lambda x, *d: x.permute(*d))(o, 0, 2, 1, 3).reshape(B, S, D) @ wo

    a = _A_ref(A_x, A_wqkv, A_wo)
    b = _B_ref(B_x, B_wqkv, B_w_phi, B_wo)
    return torch.concatenate([a, b], axis=-1)
```

```asm
; @launch grid=(512,1,1) block=(512,1,1) lds=73744
.amdgcn_target "amdgcn-amd-amdhsa--gfx950"
.text
.globl concat_heads__mha_block__linear_kernel_hedgehog__prompt_kernel
.p2align 8
.type concat_heads__mha_block__linear_kernel_hedgehog__prompt_kernel,@function
concat_heads__mha_block__linear_kernel_hedgehog__prompt_kernel:
  s_cmp_ge_u32 s2, 512
  s_cbranch_scc1 k2_end
  v_lshrrev_b32 v1, 6, v0
  v_and_b32 v115, 63, v0
  v_readfirstlane_b32 s29, v1
  s_cmp_ge_u32 s2, 256
  s_cbranch_scc1 k2_b
  s_load_dwordx4 s[4:7], s[0:1], 0
  s_load_dwordx2 s[36:37], s[0:1], 16
  s_load_dwordx2 s[30:31], s[0:1], 56
  s_load_dwordx4 s[48:51], s[0:1], 64
  s_setprio 2
  s_and_b32 s3, s2, 3
  s_lshl_b32 s3, s3, 2
  s_bfe_u32 s33, s2, 0x20003
  s_add_u32 s33, s33, s3
  s_bfe_u32 s3, s2, 0x10002
  s_lshl_b32 s3, s3, 3
  s_bfe_u32 s32, s2, 0x30005
  s_add_u32 s32, s32, s3
  s_and_b32 s3, s2, 7
  s_lshl_b32 s3, s3, 1
  s_bfe_u32 s54, s2, 0x10003
  s_add_u32 s54, s54, s3
  s_bfe_u32 s55, s2, 0x40004
  s_mul_i32 s24, s33, 80
  s_mul_i32 s25, s32, 163840
  s_lshl_b32 s83, s2, 9
  s_add_u32 s83, s83, 16400384
  v_lshrrev_b32 v119, 4, v115
  v_lshlrev_b32 v118, 2, v119
  v_xor_b32 v118, v118, v115
  v_and_b32 v118, 15, v118
  s_mov_b32 s20, 2856602192
  s_mov_b32 s21, 0
  v_mul_u32_u24 v112, 2, v118
  v_lshrrev_b64 v[116:117], v112, s[20:21]
  v_and_b32 v112, 3, v116
  v_mul_u32_u24 v112, 1280, v112
  s_mov_b32 s20, 1142956064
  s_mov_b32 s21, 1401325670
  v_mul_u32_u24 v113, 4, v118
  v_lshrrev_b64 v[116:117], v113, s[20:21]
  v_and_b32 v113, 15, v116
  v_lshl_add_u32 v112, v113, 3, v112
  s_mov_b32 s27, 3840
  v_mad_u32_u24 v112, v119, s27, v112
  v_and_b32 v116, 7, v115
  v_xor_b32 v116, v116, v119
  v_lshrrev_b32 v118, 3, v115
  v_mul_u32_u24 v118, 1280, v118
  v_lshl_add_u32 v113, v116, 4, v118
  v_xor_b32 v114, 64, v113
  s_mul_i32 s27, s29, 15360
  s_add_u32 s24, s24, s27
  s_mul_i32 s27, s29, 20480
  s_add_u32 s25, s25, s27
  s_mul_i32 s26, s29, 2048
  s_lshr_b32 s22, s26, 1
  s_waitcnt lgkmcnt(0)
  s_mov_b32 s8, s6
  s_mov_b32 s9, s7
  s_mov_b32 s10, 2457600
  s_mov_b32 s11, 0x20000
  s_mov_b32 s12, s4
  s_mov_b32 s13, s5
  s_mov_b32 s14, 2621440
  s_mov_b32 s15, 0x20000
  s_add_u32 m0, s26, 16384
  s_add_u32 s28, s25, 0
  buffer_load_dwordx4 v113, s[12:15], s28 offen  lds
  s_add_u32 m0, s26, 17408
  s_add_u32 s28, s25, 10240
  buffer_load_dwordx4 v114, s[12:15], s28 offen  lds
  s_add_u32 m0, s22, 0
  s_add_u32 s27, s24, 0
  buffer_load_dwordx4 v112, s[8:11], s27 offen  lds
  s_add_u32 m0, s22, 8192
  s_add_u32 s27, s24, 122880
  buffer_load_dwordx4 v112, s[8:11], s27 offen  lds
  s_add_u32 m0, s26, 49152
  s_add_u32 s28, s25, 128
  buffer_load_dwordx4 v113, s[12:15], s28 offen  lds
  s_add_u32 m0, s26, 50176
  s_add_u32 s28, s25, 10368
  buffer_load_dwordx4 v114, s[12:15], s28 offen  lds
  s_add_u32 m0, s22, 32768
  s_add_u32 s27, s24, 245760
  buffer_load_dwordx4 v112, s[8:11], s27 offen  lds
  s_add_u32 m0, s22, 40960
  s_add_u32 s27, s24, 368640
  buffer_load_dwordx4 v112, s[8:11], s27 offen  lds
  s_lshl_b32 s3, s29, 6
  v_add_u32 v116, s3, v115
  s_bfe_u32 s34, s2, 0x20003
  s_mul_i32 s35, s34, 40960
  s_mul_i32 s3, s32, 163840
  s_add_u32 s35, s35, s3
  v_add_u32 v117, 0, v116
  v_min_u32 v117, 319, v117
  v_lshlrev_b32 v117, 7, v117
  buffer_load_dword v124, v117, s[12:15], s35 offen
  s_bfe_u32 s3, s2, 0x30005
  s_lshl_b32 s3, s3, 2
  s_add_u32 s3, s3, s34
  s_mul_i32 s35, s3, 76800
  s_and_b32 s3, s2, 3
  s_mul_i32 s3, s3, 320
  s_add_u32 s35, s35, s3
  v_min_u32 v116, 239, v116
  v_lshrrev_b32 v117, 2, v116
  v_and_b32 v116, 3, v116
  v_mul_u32_u24 v117, 1280, v117
  v_mul_u32_u24 v116, 104, v116
  v_add_u32 v116, v116, v117
  buffer_load_dword v125, v116, s[8:11], s35 offen
  s_mov_b32 s16, s50
  s_mov_b32 s17, s51
  s_mov_b32 s18, 16695296
  s_mov_b32 s19, 0x20000
  s_mov_b32 s44, s48
  s_mov_b32 s45, s49
  s_mov_b32 s46, 256
  s_mov_b32 s47, 0x20000
  s_mov_b32 s56, s36
  s_mov_b32 s57, s37
  s_mov_b32 s58, 819200
  s_mov_b32 s59, 0x20000
  s_mov_b32 s60, s30
  s_mov_b32 s61, s31
  s_mov_b32 s62, 5242880
  s_mov_b32 s63, 0x20000
  v_lshrrev_b32 v118, 2, v115
  v_and_b32 v119, 3, v118
  v_and_b32 v118, 4, v118
  v_and_b32 v116, 3, v115
  v_or_b32 v120, v118, v116
  v_lshrrev_b32 v118, 5, v115
  v_lshl_add_u32 v118, v118, 3, v119
  v_lshlrev_b32 v121, 8, v118
  v_lshlrev_b32 v119, 3, v119
  s_mov_b32 s20, 83952640
  s_mov_b32 s21, 117638658
  v_mul_u32_u24 v104, 8, v120
  v_lshrrev_b64 v[116:117], v104, s[20:21]
  v_and_b32 v104, 255, v116
  s_mov_b32 s20, 303042317
  s_mov_b32 s21, 370414353
  v_mul_u32_u24 v106, 8, v120
  v_lshrrev_b64 v[116:117], v106, s[20:21]
  v_and_b32 v106, 255, v116
  s_cmp_ge_u32 s29, 4
  s_cselect_b64 vcc, -1, 0
  v_cndmask_b32 v104, v104, v106, vcc
  v_xor_b32 v104, v104, v119
  v_lshl_add_u32 v104, v104, 3, v121
  s_mov_b32 s20, 168300044
  s_mov_b32 s21, 253561609
  v_mul_u32_u24 v105, 8, v120
  v_lshrrev_b64 v[116:117], v105, s[20:21]
  v_and_b32 v105, 255, v116
  s_mov_b32 s20, 421402389
  s_mov_b32 s21, 337320472
  v_mul_u32_u24 v107, 8, v120
  v_lshrrev_b64 v[116:117], v107, s[20:21]
  v_and_b32 v107, 255, v116
  s_cmp_ge_u32 s29, 4
  s_cselect_b64 vcc, -1, 0
  v_cndmask_b32 v105, v105, v107, vcc
  v_xor_b32 v105, v105, v119
  v_lshl_add_u32 v105, v105, 3, v121
  v_and_b32 v116, 31, v115
  v_lshlrev_b32 v116, 7, v116
  v_lshrrev_b32 v118, 1, v115
  v_and_b32 v118, 7, v118
  v_lshrrev_b32 v119, 5, v115
  v_xor_b32 v118, v118, v119
  v_lshl_add_u32 v116, v118, 4, v116
  s_and_b32 s27, s29, 3
  s_lshl_b32 s27, s27, 12
  s_add_u32 s27, s27, 16384
  v_add_u32 v108, s27, v116
  v_xor_b32 v109, 32, v108
  v_xor_b32 v110, 64, v108
  v_xor_b32 v111, 96, v108
  s_waitcnt vmcnt(7)
  s_barrier
  ds_read_b128 v[96:99], v108 offset:0
  ds_read_b64_tr_b16 v[64:65], v104 offset:0
  ds_read_b64_tr_b16 v[66:67], v104 offset:1024
  ds_read_b64_tr_b16 v[68:69], v105 offset:0
  ds_read_b64_tr_b16 v[70:71], v105 offset:1024
  s_waitcnt lgkmcnt(2)
  v_mfma_f32_32x32x16_bf16 v[0:15], v[64:67], v[96:99], 0
  ds_read_b128 v[100:103], v109 offset:0
  ds_read_b64_tr_b16 v[80:81], v104 offset:4096
  ds_read_b64_tr_b16 v[82:83], v104 offset:5120
  ds_read_b64_tr_b16 v[84:85], v105 offset:4096
  ds_read_b64_tr_b16 v[86:87], v105 offset:5120
  ds_read_b128 v[116:119], v110 offset:0
  ds_read_b128 v[120:123], v111 offset:0
  s_waitcnt lgkmcnt(7)
  v_mfma_f32_32x32x16_bf16 v[16:31], v[68:71], v[96:99], 0
  s_waitcnt lgkmcnt(4)
  v_mfma_f32_32x32x16_bf16 v[0:15], v[80:83], v[100:103], v[0:15]
  s_waitcnt vmcnt(6) lgkmcnt(0)
  s_barrier
  ds_read_b64_tr_b16 v[64:65], v104 offset:8192
  ds_read_b64_tr_b16 v[66:67], v104 offset:9216
  ds_read_b64_tr_b16 v[68:69], v105 offset:8192
  ds_read_b64_tr_b16 v[70:71], v105 offset:9216
  v_mfma_f32_32x32x16_bf16 v[16:31], v[84:87], v[100:103], v[16:31]
  s_add_u32 m0, s22, 0
  s_add_u32 s27, s24, 491520
  buffer_load_dwordx4 v112, s[8:11], s27 offen  lds
  s_add_u32 m0, s26, 16384
  s_add_u32 s28, s25, 256
  buffer_load_dwordx4 v113, s[12:15], s28 offen  lds
  s_add_u32 m0, s26, 17408
  s_add_u32 s28, s25, 10496
  buffer_load_dwordx4 v114, s[12:15], s28 offen  lds
  s_waitcnt lgkmcnt(2)
  v_mfma_f32_32x32x16_bf16 v[0:15], v[64:67], v[116:119], v[0:15]
  ds_read_b64_tr_b16 v[80:81], v104 offset:12288
  ds_read_b64_tr_b16 v[82:83], v104 offset:13312
  ds_read_b64_tr_b16 v[84:85], v105 offset:12288
  ds_read_b64_tr_b16 v[86:87], v105 offset:13312
  s_waitcnt lgkmcnt(4)
  v_mfma_f32_32x32x16_bf16 v[16:31], v[68:71], v[116:119], v[16:31]
  s_waitcnt lgkmcnt(2)
  v_mfma_f32_32x32x16_bf16 v[0:15], v[80:83], v[120:123], v[0:15]
  s_waitcnt vmcnt(6) lgkmcnt(0)
  s_barrier
  ds_read_b128 v[96:99], v108 offset:32768
  ds_read_b64_tr_b16 v[64:65], v104 offset:32768
  ds_read_b64_tr_b16 v[66:67], v104 offset:33792
  ds_read_b64_tr_b16 v[68:69], v105 offset:32768
  ds_read_b64_tr_b16 v[70:71], v105 offset:33792
  v_mfma_f32_32x32x16_bf16 v[16:31], v[84:87], v[120:123], v[16:31]
  s_add_u32 m0, s22, 8192
  s_add_u32 s27, s24, 614400
  buffer_load_dwordx4 v112, s[8:11], s27 offen  lds
  s_waitcnt lgkmcnt(2)
  v_mfma_f32_32x32x16_bf16 v[0:15], v[64:67], v[96:99], v[0:15]
  ds_read_b128 v[100:103], v109 offset:32768
  ds_read_b64_tr_b16 v[80:81], v104 offset:36864
  ds_read_b64_tr_b16 v[82:83], v104 offset:37888
  ds_read_b64_tr_b16 v[84:85], v105 offset:36864
  ds_read_b64_tr_b16 v[86:87], v105 offset:37888
  ds_read_b128 v[116:119], v110 offset:32768
  ds_read_b128 v[120:123], v111 offset:32768
  s_waitcnt lgkmcnt(7)
  v_mfma_f32_32x32x16_bf16 v[16:31], v[68:71], v[96:99], v[16:31]
  s_waitcnt lgkmcnt(4)
  v_mfma_f32_32x32x16_bf16 v[0:15], v[80:83], v[100:103], v[0:15]
  s_waitcnt vmcnt(6) lgkmcnt(0)
  s_barrier
  ds_read_b64_tr_b16 v[64:65], v104 offset:40960
  ds_read_b64_tr_b16 v[66:67], v104 offset:41984
  ds_read_b64_tr_b16 v[68:69], v105 offset:40960
  ds_read_b64_tr_b16 v[70:71], v105 offset:41984
  v_mfma_f32_32x32x16_bf16 v[16:31], v[84:87], v[100:103], v[16:31]
  s_add_u32 m0, s22, 32768
  s_add_u32 s27, s24, 737280
  buffer_load_dwordx4 v112, s[8:11], s27 offen  lds
  s_add_u32 m0, s26, 49152
  s_add_u32 s28, s25, 384
  buffer_load_dwordx4 v113, s[12:15], s28 offen  lds
  s_add_u32 m0, s26, 50176
  s_add_u32 s28, s25, 10624
  buffer_load_dwordx4 v114, s[12:15], s28 offen  lds
  s_waitcnt lgkmcnt(2)
  v_mfma_f32_32x32x16_bf16 v[0:15], v[64:67], v[116:119], v[0:15]
  ds_read_b64_tr_b16 v[80:81], v104 offset:45056
  ds_read_b64_tr_b16 v[82:83], v104 offset:46080
  ds_read_b64_tr_b16 v[84:85], v105 offset:45056
  ds_read_b64_tr_b16 v[86:87], v105 offset:46080
  s_waitcnt lgkmcnt(4)
  v_mfma_f32_32x32x16_bf16 v[16:31], v[68:71], v[116:119], v[16:31]
  s_waitcnt lgkmcnt(2)
  v_mfma_f32_32x32x16_bf16 v[0:15], v[80:83], v[120:123], v[0:15]
  s_waitcnt vmcnt(4) lgkmcnt(0)
  s_barrier
  ds_read_b128 v[96:99], v108 offset:0
  ds_read_b64_tr_b16 v[64:65], v104 offset:0
  ds_read_b64_tr_b16 v[66:67], v104 offset:1024
  ds_read_b64_tr_b16 v[68:69], v105 offset:0
  ds_read_b64_tr_b16 v[70:71], v105 offset:1024
  v_mfma_f32_32x32x16_bf16 v[16:31], v[84:87], v[120:123], v[16:31]
  s_add_u32 m0, s22, 40960
  s_add_u32 s27, s24, 860160
  buffer_load_dwordx4 v112, s[8:11], s27 offen  lds
  s_waitcnt lgkmcnt(2)
  v_mfma_f32_32x32x16_bf16 v[0:15], v[64:67], v[96:99], v[0:15]
  ds_read_b128 v[100:103], v109 offset:0
  ds_read_b64_tr_b16 v[80:81], v104 offset:4096
  ds_read_b64_tr_b16 v[82:83], v104 offset:5120
  ds_read_b64_tr_b16 v[84:85], v105 offset:4096
  ds_read_b64_tr_b16 v[86:87], v105 offset:5120
  ds_read_b128 v[116:119], v110 offset:0
  ds_read_b128 v[120:123], v111 offset:0
  s_waitcnt lgkmcnt(7)
  v_mfma_f32_32x32x16_bf16 v[16:31], v[68:71], v[96:99], v[16:31]
  s_waitcnt lgkmcnt(4)
  v_mfma_f32_32x32x16_bf16 v[0:15], v[80:83], v[100:103], v[0:15]
  s_waitcnt vmcnt(4) lgkmcnt(0)
  s_barrier
  ds_read_b64_tr_b16 v[64:65], v104 offset:8192
  ds_read_b64_tr_b16 v[66:67], v104 offset:9216
  ds_read_b64_tr_b16 v[68:69], v105 offset:8192
  ds_read_b64_tr_b16 v[70:71], v105 offset:9216
  v_mfma_f32_32x32x16_bf16 v[16:31], v[84:87], v[100:103], v[16:31]
  s_add_u32 m0, s22, 0
  s_add_u32 s27, s24, 983040
  buffer_load_dwordx4 v112, s[8:11], s27 offen  lds
  s_add_u32 m0, s26, 16384
  s_add_u32 s28, s25, 512
  buffer_load_dwordx4 v113, s[12:15], s28 offen  lds
  s_add_u32 m0, s26, 17408
  s_add_u32 s28, s25, 10752
  buffer_load_dwordx4 v114, s[12:15], s28 offen  lds
  s_waitcnt lgkmcnt(2)
  v_mfma_f32_32x32x16_bf16 v[0:15], v[64:67], v[116:119], v[0:15]
  ds_read_b64_tr_b16 v[80:81], v104 offset:12288
  ds_read_b64_tr_b16 v[82:83], v104 offset:13312
  ds_read_b64_tr_b16 v[84:85], v105 offset:12288
  ds_read_b64_tr_b16 v[86:87], v105 offset:13312
  s_waitcnt lgkmcnt(4)
  v_mfma_f32_32x32x16_bf16 v[16:31], v[68:71], v[116:119], v[16:31]
  s_waitcnt lgkmcnt(2)
  v_mfma_f32_32x32x16_bf16 v[0:15], v[80:83], v[120:123], v[0:15]
  s_waitcnt vmcnt(4) lgkmcnt(0)
  s_barrier
  ds_read_b128 v[96:99], v108 offset:32768
  ds_read_b64_tr_b16 v[64:65], v104 offset:32768
  ds_read_b64_tr_b16 v[66:67], v104 offset:33792
  ds_read_b64_tr_b16 v[68:69], v105 offset:32768
  ds_read_b64_tr_b16 v[70:71], v105 offset:33792
  v_mfma_f32_32x32x16_bf16 v[16:31], v[84:87], v[120:123], v[16:31]
  s_add_u32 m0, s22, 8192
  s_add_u32 s27, s24, 1105920
  buffer_load_dwordx4 v112, s[8:11], s27 offen  lds
  s_waitcnt lgkmcnt(2)
  v_mfma_f32_32x32x16_bf16 v[0:15], v[64:67], v[96:99], v[0:15]
  ds_read_b128 v[100:103], v109 offset:32768
  ds_read_b64_tr_b16 v[80:81], v104 offset:36864
  ds_read_b64_tr_b16 v[82:83], v104 offset:37888
  ds_read_b64_tr_b16 v[84:85], v105 offset:36864
  ds_read_b64_tr_b16 v[86:87], v105 offset:37888
  ds_read_b128 v[116:119], v110 offset:32768
  ds_read_b128 v[120:123], v111 offset:32768
  s_waitcnt lgkmcnt(7)
  v_mfma_f32_32x32x16_bf16 v[16:31], v[68:71], v[96:99], v[16:31]
  s_waitcnt lgkmcnt(4)
  v_mfma_f32_32x32x16_bf16 v[0:15], v[80:83], v[100:103], v[0:15]
  s_waitcnt vmcnt(4) lgkmcnt(0)
  s_barrier
  ds_read_b64_tr_b16 v[64:65], v104 offset:40960
  ds_read_b64_tr_b16 v[66:67], v104 offset:41984
  ds_read_b64_tr_b16 v[68:69], v105 offset:40960
  ds_read_b64_tr_b16 v[70:71], v105 offset:41984
  v_mfma_f32_32x32x16_bf16 v[16:31], v[84:87], v[100:103], v[16:31]
  s_add_u32 m0, s22, 32768
  s_add_u32 s27, s24, 1228800
  buffer_load_dwordx4 v112, s[8:11], s27 offen  lds
  s_add_u32 m0, s26, 49152
  s_add_u32 s28, s25, 640
  buffer_load_dwordx4 v113, s[12:15], s28 offen  lds
  s_add_u32 m0, s26, 50176
  s_add_u32 s28, s25, 10880
  buffer_load_dwordx4 v114, s[12:15], s28 offen  lds
  s_waitcnt lgkmcnt(2)
  v_mfma_f32_32x32x16_bf16 v[0:15], v[64:67], v[116:119], v[0:15]
  ds_read_b64_tr_b16 v[80:81], v104 offset:45056
  ds_read_b64_tr_b16 v[82:83], v104 offset:46080
  ds_read_b64_tr_b16 v[84:85], v105 offset:45056
  ds_read_b64_tr_b16 v[86:87], v105 offset:46080
  s_waitcnt lgkmcnt(4)
  v_mfma_f32_32x32x16_bf16 v[16:31], v[68:71], v[116:119], v[16:31]
  s_waitcnt lgkmcnt(2)
  v_mfma_f32_32x32x16_bf16 v[0:15], v[80:83], v[120:123], v[0:15]
  s_waitcnt vmcnt(4) lgkmcnt(0)
  s_barrier
  ds_read_b128 v[96:99], v108 offset:0
  ds_read_b64_tr_b16 v[64:65], v104 offset:0
  ds_read_b64_tr_b16 v[66:67], v104 offset:1024
  ds_read_b64_tr_b16 v[68:69], v105 offset:0
  ds_read_b64_tr_b16 v[70:71], v105 offset:1024
  v_mfma_f32_32x32x16_bf16 v[16:31], v[84:87], v[120:123], v[16:31]
  s_add_u32 m0, s22, 40960
  s_add_u32 s27, s24, 1351680
  buffer_load_dwordx4 v112, s[8:11], s27 offen  lds
  s_waitcnt lgkmcnt(2)
  v_mfma_f32_32x32x16_bf16 v[0:15], v[64:67], v[96:99], v[0:15]
  ds_read_b128 v[100:103], v109 offset:0
  ds_read_b64_tr_b16 v[80:81], v104 offset:4096
  ds_read_b64_tr_b16 v[82:83], v104 offset:5120
  ds_read_b64_tr_b16 v[84:85], v105 offset:4096
  ds_read_b64_tr_b16 v[86:87], v105 offset:5120
  ds_read_b128 v[116:119], v110 offset:0
  ds_read_b128 v[120:123], v111 offset:0
  s_waitcnt lgkmcnt(7)
  v_mfma_f32_32x32x16_bf16 v[16:31], v[68:71], v[96:99], v[16:31]
  s_waitcnt lgkmcnt(4)
  v_mfma_f32_32x32x16_bf16 v[0:15], v[80:83], v[100:103], v[0:15]
  s_waitcnt vmcnt(4) lgkmcnt(0)
  s_barrier
  ds_read_b64_tr_b16 v[64:65], v104 offset:8192
  ds_read_b64_tr_b16 v[66:67], v104 offset:9216
  ds_read_b64_tr_b16 v[68:69], v105 offset:8192
  ds_read_b64_tr_b16 v[70:71], v105 offset:9216
  v_mfma_f32_32x32x16_bf16 v[16:31], v[84:87], v[100:103], v[16:31]
  s_add_u32 m0, s22, 0
  s_add_u32 s27, s24, 1474560
  buffer_load_dwordx4 v112, s[8:11], s27 offen  lds
  s_add_u32 m0, s26, 16384
  s_add_u32 s28, s25, 768
  buffer_load_dwordx4 v113, s[12:15], s28 offen  lds
  s_add_u32 m0, s26, 17408
  s_add_u32 s28, s25, 11008
  buffer_load_dwordx4 v114, s[12:15], s28 offen  lds
  s_waitcnt lgkmcnt(2)
  v_mfma_f32_32x32x16_bf16 v[0:15], v[64:67], v[116:119], v[0:15]
  ds_read_b64_tr_b16 v[80:81], v104 offset:12288
  ds_read_b64_tr_b16 v[82:83], v104 offset:13312
  ds_read_b64_tr_b16 v[84:85], v105 offset:12288
  ds_read_b64_tr_b16 v[86:87], v105 offset:13312
  s_waitcnt lgkmcnt(4)
  v_mfma_f32_32x32x16_bf16 v[16:31], v[68:71], v[116:119], v[16:31]
  s_waitcnt lgkmcnt(2)
  v_mfma_f32_32x32x16_bf16 v[0:15], v[80:83], v[120:123], v[0:15]
  s_waitcnt vmcnt(4) lgkmcnt(0)
  s_barrier
  ds_read_b128 v[96:99], v108 offset:32768
  ds_read_b64_tr_b16 v[64:65], v104 offset:32768
  ds_read_b64_tr_b16 v[66:67], v104 offset:33792
  ds_read_b64_tr_b16 v[68:69], v105 offset:32768
  ds_read_b64_tr_b16 v[70:71], v105 offset:33792
  v_mfma_f32_32x32x16_bf16 v[16:31], v[84:87], v[120:123], v[16:31]
  s_add_u32 m0, s22, 8192
  s_add_u32 s27, s24, 1597440
  buffer_load_dwordx4 v112, s[8:11], s27 offen  lds
  s_waitcnt lgkmcnt(2)
  v_mfma_f32_32x32x16_bf16 v[0:15], v[64:67], v[96:99], v[0:15]
  ds_read_b128 v[100:103], v109 offset:32768
  ds_read_b64_tr_b16 v[80:81], v104 offset:36864
  ds_read_b64_tr_b16 v[82:83], v104 offset:37888
  ds_read_b64_tr_b16 v[84:85], v105 offset:36864
  ds_read_b64_tr_b16 v[86:87], v105 offset:37888
  ds_read_b128 v[116:119], v110 offset:32768
  ds_read_b128 v[120:123], v111 offset:32768
  s_waitcnt lgkmcnt(7)
  v_mfma_f32_32x32x16_bf16 v[16:31], v[68:71], v[96:99], v[16:31]
  s_waitcnt lgkmcnt(4)
  v_mfma_f32_32x32x16_bf16 v[0:15], v[80:83], v[100:103], v[0:15]
  s_waitcnt vmcnt(4) lgkmcnt(0)
  s_barrier
  ds_read_b64_tr_b16 v[64:65], v104 offset:40960
  ds_read_b64_tr_b16 v[66:67], v104 offset:41984
  ds_read_b64_tr_b16 v[68:69], v105 offset:40960
  ds_read_b64_tr_b16 v[70:71], v105 offset:41984
  v_mfma_f32_32x32x16_bf16 v[16:31], v[84:87], v[100:103], v[16:31]
  s_add_u32 m0, s22, 32768
  s_add_u32 s27, s24, 1720320
  buffer_load_dwordx4 v112, s[8:11], s27 offen  lds
  s_add_u32 m0, s26, 49152
  s_add_u32 s28, s25, 896
  buffer_load_dwordx4 v113, s[12:15], s28 offen  lds
  s_add_u32 m0, s26, 50176
  s_add_u32 s28, s25, 11136
  buffer_load_dwordx4 v114, s[12:15], s28 offen  lds
  s_waitcnt lgkmcnt(2)
  v_mfma_f32_32x32x16_bf16 v[0:15], v[64:67], v[116:119], v[0:15]
  ds_read_b64_tr_b16 v[80:81], v104 offset:45056
  ds_read_b64_tr_b16 v[82:83], v104 offset:46080
  ds_read_b64_tr_b16 v[84:85], v105 offset:45056
  ds_read_b64_tr_b16 v[86:87], v105 offset:46080
  s_waitcnt lgkmcnt(4)
  v_mfma_f32_32x32x16_bf16 v[16:31], v[68:71], v[116:119], v[16:31]
  s_waitcnt lgkmcnt(2)
  v_mfma_f32_32x32x16_bf16 v[0:15], v[80:83], v[120:123], v[0:15]
  s_waitcnt vmcnt(4) lgkmcnt(0)
  s_barrier
  ds_read_b128 v[96:99], v108 offset:0
  ds_read_b64_tr_b16 v[64:65], v104 offset:0
  ds_read_b64_tr_b16 v[66:67], v104 offset:1024
  ds_read_b64_tr_b16 v[68:69], v105 offset:0
  ds_read_b64_tr_b16 v[70:71], v105 offset:1024
  v_mfma_f32_32x32x16_bf16 v[16:31], v[84:87], v[120:123], v[16:31]
  s_add_u32 m0, s22, 40960
  s_add_u32 s27, s24, 1843200
  buffer_load_dwordx4 v112, s[8:11], s27 offen  lds
  s_waitcnt lgkmcnt(2)
  v_mfma_f32_32x32x16_bf16 v[0:15], v[64:67], v[96:99], v[0:15]
  ds_read_b128 v[100:103], v109 offset:0
  ds_read_b64_tr_b16 v[80:81], v104 offset:4096
  ds_read_b64_tr_b16 v[82:83], v104 offset:5120
  ds_read_b64_tr_b16 v[84:85], v105 offset:4096
  ds_read_b64_tr_b16 v[86:87], v105 offset:5120
  ds_read_b128 v[116:119], v110 offset:0
  ds_read_b128 v[120:123], v111 offset:0
  s_waitcnt lgkmcnt(7)
  v_mfma_f32_32x32x16_bf16 v[16:31], v[68:71], v[96:99], v[16:31]
  s_waitcnt lgkmcnt(4)
  v_mfma_f32_32x32x16_bf16 v[0:15], v[80:83], v[100:103], v[0:15]
  s_waitcnt vmcnt(4) lgkmcnt(0)
  s_barrier
  ds_read_b64_tr_b16 v[64:65], v104 offset:8192
  ds_read_b64_tr_b16 v[66:67], v104 offset:9216
  ds_read_b64_tr_b16 v[68:69], v105 offset:8192
  ds_read_b64_tr_b16 v[70:71], v105 offset:9216
  v_mfma_f32_32x32x16_bf16 v[16:31], v[84:87], v[100:103], v[16:31]
  s_add_u32 m0, s22, 0
  s_add_u32 s27, s24, 1966080
  buffer_load_dwordx4 v112, s[8:11], s27 offen  lds
  s_add_u32 m0, s26, 16384
  s_add_u32 s28, s25, 1024
  buffer_load_dwordx4 v113, s[12:15], s28 offen  lds
  s_add_u32 m0, s26, 17408
  s_add_u32 s28, s25, 11264
  buffer_load_dwordx4 v114, s[12:15], s28 offen  lds
  s_waitcnt lgkmcnt(2)
  v_mfma_f32_32x32x16_bf16 v[0:15], v[64:67], v[116:119], v[0:15]
  ds_read_b64_tr_b16 v[80:81], v104 offset:12288
  ds_read_b64_tr_b16 v[82:83], v104 offset:13312
  ds_read_b64_tr_b16 v[84:85], v105 offset:12288
  ds_read_b64_tr_b16 v[86:87], v105 offset:13312
  s_waitcnt lgkmcnt(4)
  v_mfma_f32_32x32x16_bf16 v[16:31], v[68:71], v[116:119], v[16:31]
  s_waitcnt lgkmcnt(2)
  v_mfma_f32_32x32x16_bf16 v[0:15], v[80:83], v[120:123], v[0:15]
  s_waitcnt vmcnt(4) lgkmcnt(0)
  s_barrier
  ds_read_b128 v[96:99], v108 offset:32768
  ds_read_b64_tr_b16 v[64:65], v104 offset:32768
  ds_read_b64_tr_b16 v[66:67], v104 offset:33792
  ds_read_b64_tr_b16 v[68:69], v105 offset:32768
  ds_read_b64_tr_b16 v[70:71], v105 offset:33792
  v_mfma_f32_32x32x16_bf16 v[16:31], v[84:87], v[120:123], v[16:31]
  s_add_u32 m0, s22, 8192
  s_add_u32 s27, s24, 2088960
  buffer_load_dwordx4 v112, s[8:11], s27 offen  lds
  s_waitcnt lgkmcnt(2)
  v_mfma_f32_32x32x16_bf16 v[0:15], v[64:67], v[96:99], v[0:15]
  ds_read_b128 v[100:103], v109 offset:32768
  ds_read_b64_tr_b16 v[80:81], v104 offset:36864
  ds_read_b64_tr_b16 v[82:83], v104 offset:37888
  ds_read_b64_tr_b16 v[84:85], v105 offset:36864
  ds_read_b64_tr_b16 v[86:87], v105 offset:37888
  ds_read_b128 v[116:119], v110 offset:32768
  ds_read_b128 v[120:123], v111 offset:32768
  s_waitcnt lgkmcnt(7)
  v_mfma_f32_32x32x16_bf16 v[16:31], v[68:71], v[96:99], v[16:31]
  s_waitcnt lgkmcnt(4)
  v_mfma_f32_32x32x16_bf16 v[0:15], v[80:83], v[100:103], v[0:15]
  s_cmp_lg_u32 s29, 0
  s_cbranch_scc1 a_h0
  v_mov_b32 v126, 0
  buffer_load_dword v126, v126, s[44:47], 0 offen offset:128 sc1
a_h0:
  s_waitcnt vmcnt(4) lgkmcnt(0)
  s_barrier
  ds_read_b64_tr_b16 v[64:65], v104 offset:40960
  ds_read_b64_tr_b16 v[66:67], v104 offset:41984
  ds_read_b64_tr_b16 v[68:69], v105 offset:40960
  ds_read_b64_tr_b16 v[70:71], v105 offset:41984
  v_mfma_f32_32x32x16_bf16 v[16:31], v[84:87], v[100:103], v[16:31]
  s_add_u32 m0, s22, 32768
  s_add_u32 s27, s24, 2211840
  buffer_load_dwordx4 v112, s[8:11], s27 offen  lds
  s_add_u32 m0, s26, 49152
  s_add_u32 s28, s25, 1152
  buffer_load_dwordx4 v113, s[12:15], s28 offen  lds
  s_add_u32 m0, s26, 50176
  s_add_u32 s28, s25, 11392
  buffer_load_dwordx4 v114, s[12:15], s28 offen  lds
  s_waitcnt lgkmcnt(2)
  v_mfma_f32_32x32x16_bf16 v[0:15], v[64:67], v[116:119], v[0:15]
  ds_read_b64_tr_b16 v[80:81], v104 offset:45056
  ds_read_b64_tr_b16 v[82:83], v104 offset:46080
  ds_read_b64_tr_b16 v[84:85], v105 offset:45056
  ds_read_b64_tr_b16 v[86:87], v105 offset:46080
  s_waitcnt lgkmcnt(4)
  v_mfma_f32_32x32x16_bf16 v[16:31], v[68:71], v[116:119], v[16:31]
  s_waitcnt lgkmcnt(2)
  v_mfma_f32_32x32x16_bf16 v[0:15], v[80:83], v[120:123], v[0:15]
  s_waitcnt vmcnt(4) lgkmcnt(0)
  s_barrier
  ds_read_b128 v[96:99], v108 offset:0
  ds_read_b64_tr_b16 v[64:65], v104 offset:0
  ds_read_b64_tr_b16 v[66:67], v104 offset:1024
  ds_read_b64_tr_b16 v[68:69], v105 offset:0
  ds_read_b64_tr_b16 v[70:71], v105 offset:1024
  v_mfma_f32_32x32x16_bf16 v[16:31], v[84:87], v[120:123], v[16:31]
  s_add_u32 m0, s22, 40960
  s_add_u32 s27, s24, 2334720
  buffer_load_dwordx4 v112, s[8:11], s27 offen  lds
  s_waitcnt lgkmcnt(2)
  v_mfma_f32_32x32x16_bf16 v[0:15], v[64:67], v[96:99], v[0:15]
  ds_read_b128 v[100:103], v109 offset:0
  ds_read_b64_tr_b16 v[80:81], v104 offset:4096
  ds_read_b64_tr_b16 v[82:83], v104 offset:5120
  ds_read_b64_tr_b16 v[84:85], v105 offset:4096
  ds_read_b64_tr_b16 v[86:87], v105 offset:5120
  ds_read_b128 v[116:119], v110 offset:0
  ds_read_b128 v[120:123], v111 offset:0
  s_waitcnt lgkmcnt(7)
  v_mfma_f32_32x32x16_bf16 v[16:31], v[68:71], v[96:99], v[16:31]
  s_waitcnt lgkmcnt(4)
  v_mfma_f32_32x32x16_bf16 v[0:15], v[80:83], v[100:103], v[0:15]
  s_waitcnt vmcnt(4) lgkmcnt(0)
  s_barrier
  ds_read_b64_tr_b16 v[64:65], v104 offset:8192
  ds_read_b64_tr_b16 v[66:67], v104 offset:9216
  ds_read_b64_tr_b16 v[68:69], v105 offset:8192
  ds_read_b64_tr_b16 v[70:71], v105 offset:9216
  v_mfma_f32_32x32x16_bf16 v[16:31], v[84:87], v[100:103], v[16:31]
  s_waitcnt lgkmcnt(2)
  v_mfma_f32_32x32x16_bf16 v[0:15], v[64:67], v[116:119], v[0:15]
  ds_read_b64_tr_b16 v[80:81], v104 offset:12288
  ds_read_b64_tr_b16 v[82:83], v104 offset:13312
  ds_read_b64_tr_b16 v[84:85], v105 offset:12288
  ds_read_b64_tr_b16 v[86:87], v105 offset:13312
  s_waitcnt lgkmcnt(4)
  v_mfma_f32_32x32x16_bf16 v[16:31], v[68:71], v[116:119], v[16:31]
  s_waitcnt lgkmcnt(2)
  v_mfma_f32_32x32x16_bf16 v[0:15], v[80:83], v[120:123], v[0:15]
  s_waitcnt vmcnt(1) lgkmcnt(0)
  s_barrier
  ds_read_b128 v[96:99], v108 offset:32768
  ds_read_b64_tr_b16 v[64:65], v104 offset:32768
  ds_read_b64_tr_b16 v[66:67], v104 offset:33792
  ds_read_b64_tr_b16 v[68:69], v105 offset:32768
  ds_read_b64_tr_b16 v[70:71], v105 offset:33792
  v_mfma_f32_32x32x16_bf16 v[16:31], v[84:87], v[120:123], v[16:31]
  s_waitcnt lgkmcnt(2)
  v_mfma_f32_32x32x16_bf16 v[0:15], v[64:67], v[96:99], v[0:15]
  s_cmp_lg_u32 s29, 0
  s_cbranch_scc1 a_h1
  v_readfirstlane_b32 s52, v126
  s_nop 1
  s_cmpk_ge_u32 s52, 256
  s_cbranch_scc1 a_h2
  s_mov_b64 exec, 1
  v_lshlrev_b32 v125, 2, v115
  s_mov_b32 s53, 0
a_hi_p:
  s_add_u32 s53, s53, 1
  s_cmp_ge_u32 s53, 0x100000
  s_cbranch_scc1 a_hi_e
  buffer_load_dword v126, v125, s[44:47], 0 offen offset:128 sc1
  s_waitcnt vmcnt(0)
  v_cmp_gt_u32 vcc, 0x100, v126
  s_cbranch_vccnz a_hi_p
a_hi_e:
  s_mov_b64 exec, -1
a_h2:
  s_add_u32 s52, s83, 131072
  v_mov_b32 v127, 1
  s_mov_b64 exec, 1
  buffer_store_dword v127, off, s[16:19], s52 offset:256 sc1
  s_mov_b64 exec, -1
a_h1:
  ds_read_b128 v[100:103], v109 offset:32768
  ds_read_b64_tr_b16 v[80:81], v104 offset:36864
  ds_read_b64_tr_b16 v[82:83], v104 offset:37888
  ds_read_b64_tr_b16 v[84:85], v105 offset:36864
  ds_read_b64_tr_b16 v[86:87], v105 offset:37888
  ds_read_b128 v[116:119], v110 offset:32768
  ds_read_b128 v[120:123], v111 offset:32768
  s_waitcnt lgkmcnt(7)
  v_mfma_f32_32x32x16_bf16 v[16:31], v[68:71], v[96:99], v[16:31]
  s_waitcnt lgkmcnt(4)
  v_mfma_f32_32x32x16_bf16 v[0:15], v[80:83], v[100:103], v[0:15]
  s_waitcnt vmcnt(0) lgkmcnt(0)
  s_barrier
  ds_read_b64_tr_b16 v[64:65], v104 offset:40960
  ds_read_b64_tr_b16 v[66:67], v104 offset:41984
  ds_read_b64_tr_b16 v[68:69], v105 offset:40960
  ds_read_b64_tr_b16 v[70:71], v105 offset:41984
  v_mfma_f32_32x32x16_bf16 v[16:31], v[84:87], v[100:103], v[16:31]
  s_waitcnt lgkmcnt(2)
  v_mfma_f32_32x32x16_bf16 v[0:15], v[64:67], v[116:119], v[0:15]
  ds_read_b64_tr_b16 v[80:81], v104 offset:45056
  ds_read_b64_tr_b16 v[82:83], v104 offset:46080
  ds_read_b64_tr_b16 v[84:85], v105 offset:45056
  ds_read_b64_tr_b16 v[86:87], v105 offset:46080
  s_waitcnt lgkmcnt(4)
  v_mfma_f32_32x32x16_bf16 v[16:31], v[68:71], v[116:119], v[16:31]
  s_waitcnt lgkmcnt(2)
  v_mfma_f32_32x32x16_bf16 v[0:15], v[80:83], v[120:123], v[0:15]
  s_waitcnt lgkmcnt(0)
  v_mfma_f32_32x32x16_bf16 v[16:31], v[84:87], v[120:123], v[16:31]
  s_lshr_b32 s39, s29, 2
  s_lshl_b32 s3, s33, 1
  s_add_u32 s3, s3, s39
  s_mul_i32 s38, s3, 98304
  s_mov_b32 s37, 0
  v_and_b32 v88, 31, v115
  v_lshrrev_b32 v89, 5, v115
  v_mul_u32_u24 v88, 48, v88
  v_lshl_add_u32 v84, v89, 4, v88
  v_add_u32 v85, 32, v88
  v_cmp_gt_u32 vcc, 32, v115
  v_mov_b32 v90, 1051011932
  s_nop 0
  v_cndmask_b32 v90, 1.0, v90, vcc
  v_mov_b32 v91, 6144
  v_cndmask_b32 v91, 0, v91, vcc
  s_lshl_b32 s3, s32, 2
  s_and_b32 s34, s29, 3
  s_add_u32 s43, s3, s34
  s_mul_i32 s31, s43, 40960
  s_mul_i32 s30, s39, 12288
  s_mul_i32 s34, s34, 1536
  s_add_u32 s34, s34, s30
  v_add3_u32 v91, v91, v85, s34
  v_add_u32 v92, s34, v84
  v_cvt_pk_bf16_f32 v36, v20, v21
  v_cvt_pk_bf16_f32 v37, v22, v23
  v_cvt_pk_bf16_f32 v38, v24, v25
  v_cvt_pk_bf16_f32 v39, v26, v27
  ds_write_b128 v92, v[36:39] offset:6144
  v_mul_f32 v0, v90, v0
  v_mul_f32 v1, v90, v1
  v_mul_f32 v2, v90, v2
  v_mul_f32 v3, v90, v3
  v_mul_f32 v4, v90, v4
  v_mul_f32 v5, v90, v5
  v_mul_f32 v6, v90, v6
  v_mul_f32 v7, v90, v7
  v_mul_f32 v8, v90, v8
  v_mul_f32 v9, v90, v9
  v_mul_f32 v10, v90, v10
  v_mul_f32 v11, v90, v11
  v_mul_f32 v12, v90, v12
  v_mul_f32 v13, v90, v13
  v_mul_f32 v14, v90, v14
  v_mul_f32 v15, v90, v15
  v_mul_f32 v16, v90, v16
  v_mul_f32 v17, v90, v17
  v_mul_f32 v18, v90, v18
  v_mul_f32 v19, v90, v19
  v_cvt_pk_bf16_f32 v72, v0, v1
  v_cvt_pk_bf16_f32 v32, v8, v9
  v_cvt_pk_bf16_f32 v73, v2, v3
  v_cvt_pk_bf16_f32 v33, v10, v11
  v_cvt_pk_bf16_f32 v74, v4, v5
  v_cvt_pk_bf16_f32 v34, v12, v13
  v_cvt_pk_bf16_f32 v75, v6, v7
  v_cvt_pk_bf16_f32 v35, v14, v15
  v_permlane32_swap_b32 v72, v32
  v_permlane32_swap_b32 v73, v33
  v_permlane32_swap_b32 v74, v34
  v_permlane32_swap_b32 v75, v35
  ds_write_b128 v92, v[32:35]
  v_cvt_pk_bf16_f32 v44, v16, v17
  v_cvt_pk_bf16_f32 v45, v18, v19
  v_cvt_pk_bf16_f32 v46, v28, v29
  v_cvt_pk_bf16_f32 v47, v30, v31
  v_cndmask_b32 v40, v44, v46, vcc
  v_cndmask_b32 v41, v45, v47, vcc
  v_mov_b32 v42, 0x3f803f80
  v_mov_b32 v43, 0x3f80
  ds_write_b128 v91, v[40:43]
  v_cndmask_b32 v76, 0, v44, vcc
  v_cndmask_b32 v77, 0, v45, vcc
  v_mov_b32 v88, 0
  v_mov_b32 v89, 73728
  ds_write_b32 v89, v88
  v_lshlrev_b32 v83, 4, v115
  s_bfe_u32 s40, s29, 0x10001
  s_mul_i32 s40, s40, 3145728
  s_and_b32 s3, s29, 1
  s_mul_i32 s3, s3, 3072
  s_add_u32 s40, s40, s3
  s_add_u32 s40, s40, s38
  s_add_u32 s40, s40, 3145728
  s_mul_i32 s41, s29, 3072
  s_mul_i32 s3, s32, 6144
  s_add_u32 s34, s40, s3
  s_add_u32 s42, s40, 98304
  v_add_u32 v94, s41, v83
  v_add_u32 v80, s30, v84
  v_add_u32 v81, s30, v85
  v_mov_b32 v78, 0
  v_mov_b32 v79, 0
  s_waitcnt lgkmcnt(0)
  s_barrier
  ds_read_b128 v[56:59], v80
  ds_read_b128 v[60:63], v81
  ds_read_b128 v[96:99], v94 offset:0
  ds_read_b128 v[100:103], v94 offset:1024
  ds_read_b128 v[104:107], v94 offset:2048
  v_lshrrev_b32 v88, 2, v115
  v_and_b32 v89, 3, v88
  v_and_b32 v88, 4, v88
  v_and_b32 v90, 3, v115
  v_or_b32 v92, v88, v90
  v_lshrrev_b32 v88, 5, v115
  v_lshl_add_u32 v89, v88, 2, v89
  v_mul_u32_u24 v93, 48, v89
  s_lshl_b32 s3, s39, 3
  v_add_u32 v92, s3, v92
  s_mov_b32 s20, 1431580960
  s_mov_b32 s21, 1431323185
  v_mul_u32_u24 v87, 4, v92
  v_lshrrev_b64 v[90:91], v87, s[20:21]
  v_and_b32 v87, 15, v90
  v_lshl_add_u32 v87, v87, 3, v93
  s_add_u32 s3, s30, 6144
  v_add_u32 v87, s3, v87
  v_mov_b32 v82, v87
  s_waitcnt lgkmcnt(3)
  v_mfma_f32_32x32x16_bf16 v[0:15], v[56:59], v[72:75], 0
  v_mfma_f32_32x32x16_bf16 v[0:15], v[60:63], v[76:79], v[0:15]
  s_waitcnt lgkmcnt(2)
  buffer_store_dwordx4 v[96:99], v83, s[16:19], s34 offen offset:0 sc1
  s_waitcnt lgkmcnt(1)
  buffer_store_dwordx4 v[100:103], v83, s[16:19], s34 offen offset:1024 sc1
  s_waitcnt lgkmcnt(0)
  buffer_store_dwordx4 v[104:107], v83, s[16:19], s34 offen offset:2048 sc1
  s_nop 5
  v_max3_f32 v86, v0, v1, v2
  v_max3_f32 v86, v86, v3, v4
  v_max3_f32 v86, v86, v5, v6
  v_max3_f32 v86, v86, v7, v8
  v_max3_f32 v86, v86, v9, v10
  v_max3_f32 v86, v86, v11, v12
  v_max3_f32 v86, v86, v13, v14
  v_max_f32 v86, v86, v15
  v_mov_b32 v88, v86
  s_nop 1
  v_permlane32_swap_b32 v86, v88
  v_max_f32 v86, v86, v88
  v_xor_b32 v86, 0x80000000, v86
  v_and_b32 v88, 0xffff0000, v86
  v_sub_f32 v86, v86, v88
  v_and_b32 v89, 0xffff0000, v86
  v_sub_f32 v86, v86, v89
  v_lshrrev_b32 v88, 16, v88
  v_or_b32 v88, v88, v89
  v_lshrrev_b32 v86, 16, v86
  v_cmp_gt_u32 vcc, 32, v115
  s_nop 1
  v_cndmask_b32 v78, 0, v88, vcc
  v_cndmask_b32 v79, 0, v86, vcc
  v_mov_b32 v32, 0
  v_mov_b32 v33, 0
  v_mov_b32 v34, 0
  v_mov_b32 v35, 0
  v_mov_b32 v36, 0
  v_mov_b32 v37, 0
  v_mov_b32 v38, 0
  v_mov_b32 v39, 0
  v_mov_b32 v40, 0
  v_mov_b32 v41, 0
  v_mov_b32 v42, 0
  v_mov_b32 v43, 0
  v_mov_b32 v44, 0
  v_mov_b32 v45, 0
  v_mov_b32 v46, 0
  v_mov_b32 v47, 0
  v_mov_b32 v52, 0
  v_mov_b32 v68, 0
  v_mov_b32 v53, 0
  v_mov_b32 v69, 0
  v_mov_b32 v54, 0
  v_mov_b32 v70, 0
  v_mov_b32 v55, 0
  v_mov_b32 v71, 0
  s_setprio 1
  v_mfma_f32_32x32x16_bf16 v[0:15], v[56:59], v[72:75], 0
  v_mfma_f32_32x32x16_bf16 v[0:15], v[60:63], v[76:79], v[0:15]
  ds_read_b128 v[56:59], v80 offset:1536
  ds_read_b128 v[60:63], v81 offset:1536
  s_waitcnt lgkmcnt(0)
  s_waitcnt lgkmcnt(3)
  v_mfma_f32_32x32x16_bf16 v[16:31], v[56:59], v[72:75], 0
  ds_read_b64_tr_b16 v[64:65], v82 offset:0
  ds_read_b64_tr_b16 v[66:67], v82 offset:384
  s_nop 4
  v_exp_f32 v0, v0
  v_exp_f32 v1, v1
  v_exp_f32 v2, v2
  v_exp_f32 v3, v3
  v_cvt_pk_bf16_f32 v48, v0, v1
  v_cvt_pk_bf16_f32 v49, v2, v3
  s_waitcnt lgkmcnt(3)
  v_mfma_f32_32x32x16_bf16 v[32:47], v[68:71], v[52:55], v[32:47]
  ds_read_b128 v[56:59], v80 offset:3072
  v_exp_f32 v4, v4
  v_exp_f32 v5, v5
  v_exp_f32 v6, v6
  v_exp_f32 v7, v7
  v_cvt_pk_bf16_f32 v50, v4, v5
  v_cvt_pk_bf16_f32 v51, v6, v7
  s_waitcnt lgkmcnt(3)
  v_mfma_f32_32x32x16_bf16 v[16:31], v[60:63], v[76:79], v[16:31]
  ds_read_b64_tr_b16 v[68:69], v82 offset:768
  ds_read_b64_tr_b16 v[70:71], v82 offset:1152
  v_exp_f32 v8, v8
  v_exp_f32 v9, v9
  v_exp_f32 v10, v10
  v_exp_f32 v11, v11
  v_cvt_pk_bf16_f32 v52, v8, v9
  v_cvt_pk_bf16_f32 v53, v10, v11
  s_waitcnt lgkmcnt(3)
  v_mfma_f32_32x32x16_bf16 v[32:47], v[64:67], v[48:51], v[32:47]
  ds_read_b128 v[60:63], v81 offset:3072
  v_exp_f32 v12, v12
  v_exp_f32 v13, v13
  v_exp_f32 v14, v14
  v_exp_f32 v15, v15
  v_cvt_pk_bf16_f32 v54, v12, v13
  v_cvt_pk_bf16_f32 v55, v14, v15
  s_waitcnt lgkmcnt(3)
  v_mfma_f32_32x32x16_bf16 v[0:15], v[56:59], v[72:75], 0
  ds_read_b64_tr_b16 v[64:65], v82 offset:1536
  ds_read_b64_tr_b16 v[66:67], v82 offset:1920
  v_exp_f32 v16, v16
  v_exp_f32 v17, v17
  v_exp_f32 v18, v18
  v_exp_f32 v19, v19
  v_cvt_pk_bf16_f32 v48, v16, v17
  v_cvt_pk_bf16_f32 v49, v18, v19
  s_waitcnt vmcnt(0)
  s_barrier
  s_cmp_lg_u32 s29, 0
  s_cbranch_scc1 aq_s
  s_and_b32 s3, s2, 0x11b
  v_lshrrev_b32 v88, 3, v115
  v_and_b32 v89, 7, v115
  v_lshlrev_b32 v88, 2, v88
  v_lshl_or_b32 v88, v89, 5, v88
  s_lshl_b32 s52, s32, 2
  v_or_b32 v88, s3, v88
  v_lshlrev_b32 v88, 9, v88
  v_mov_b32 v89, 1
  s_add_u32 s52, s52, 16400384
  s_mov_b64 exec, 0xffff
  buffer_store_dword v89, v88, s[16:19], s52 offen offset:0 sc1
  s_mov_b64 exec, -1
aq_s:
  s_waitcnt lgkmcnt(3)
  v_mfma_f32_32x32x16_bf16 v[32:47], v[68:71], v[52:55], v[32:47]
  ds_read_b128 v[56:59], v80 offset:4608
  v_exp_f32 v20, v20
  v_exp_f32 v21, v21
  v_exp_f32 v22, v22
  v_exp_f32 v23, v23
  v_cvt_pk_bf16_f32 v50, v20, v21
  v_cvt_pk_bf16_f32 v51, v22, v23
  s_waitcnt lgkmcnt(3)
  v_mfma_f32_32x32x16_bf16 v[0:15], v[60:63], v[76:79], v[0:15]
  ds_read_b64_tr_b16 v[68:69], v82 offset:2304
  ds_read_b64_tr_b16 v[70:71], v82 offset:2688
  v_exp_f32 v24, v24
  v_exp_f32 v25, v25
  v_exp_f32 v26, v26
  v_exp_f32 v27, v27
  v_cvt_pk_bf16_f32 v52, v24, v25
  v_cvt_pk_bf16_f32 v53, v26, v27
  s_waitcnt lgkmcnt(3)
  v_mfma_f32_32x32x16_bf16 v[32:47], v[64:67], v[48:51], v[32:47]
  ds_read_b128 v[60:63], v81 offset:4608
  v_exp_f32 v28, v28
  v_exp_f32 v29, v29
  v_exp_f32 v30, v30
  v_exp_f32 v31, v31
  v_cvt_pk_bf16_f32 v54, v28, v29
  v_cvt_pk_bf16_f32 v55, v30, v31
  s_waitcnt lgkmcnt(0)
  v_mfma_f32_32x32x16_bf16 v[16:31], v[56:59], v[72:75], 0
  ds_read_b64_tr_b16 v[64:65], v82 offset:3072
  ds_read_b64_tr_b16 v[66:67], v82 offset:3456
  v_exp_f32 v0, v0
  v_exp_f32 v1, v1
  v_exp_f32 v2, v2
  v_exp_f32 v3, v3
  v_cvt_pk_bf16_f32 v48, v0, v1
  v_cvt_pk_bf16_f32 v49, v2, v3
  s_waitcnt lgkmcnt(0)
  v_mfma_f32_32x32x16_bf16 v[32:47], v[68:71], v[52:55], v[32:47]
  v_exp_f32 v4, v4
  v_exp_f32 v5, v5
  v_exp_f32 v6, v6
  v_exp_f32 v7, v7
  v_cvt_pk_bf16_f32 v50, v4, v5
  v_cvt_pk_bf16_f32 v51, v6, v7
  s_waitcnt lgkmcnt(0)
  v_mfma_f32_32x32x16_bf16 v[16:31], v[60:63], v[76:79], v[16:31]
  ds_read_b64_tr_b16 v[68:69], v82 offset:3840
  ds_read_b64_tr_b16 v[70:71], v82 offset:4224
  v_exp_f32 v8, v8
  v_exp_f32 v9, v9
  v_exp_f32 v10, v10
  v_exp_f32 v11, v11
  v_cvt_pk_bf16_f32 v52, v8, v9
  v_cvt_pk_bf16_f32 v53, v10, v11
  s_waitcnt lgkmcnt(0)
  v_mfma_f32_32x32x16_bf16 v[32:47], v[64:67], v[48:51], v[32:47]
  v_exp_f32 v12, v12
  v_exp_f32 v13, v13
  v_exp_f32 v14, v14
  v_exp_f32 v15, v15
  v_cvt_pk_bf16_f32 v54, v12, v13
  v_cvt_pk_bf16_f32 v55, v14, v15
  s_waitcnt lgkmcnt(0)
  ds_read_b64_tr_b16 v[64:65], v82 offset:4608
  ds_read_b64_tr_b16 v[66:67], v82 offset:4992
  v_exp_f32 v16, v16
  v_exp_f32 v17, v17
  v_exp_f32 v18, v18
  v_exp_f32 v19, v19
  v_cvt_pk_bf16_f32 v48, v16, v17
  v_cvt_pk_bf16_f32 v49, v18, v19
  s_waitcnt lgkmcnt(0)
  v_mfma_f32_32x32x16_bf16 v[32:47], v[68:71], v[52:55], v[32:47]
  v_exp_f32 v20, v20
  v_exp_f32 v21, v21
  v_exp_f32 v22, v22
  v_exp_f32 v23, v23
  v_cvt_pk_bf16_f32 v50, v20, v21
  v_cvt_pk_bf16_f32 v51, v22, v23
  s_waitcnt lgkmcnt(0)
  ds_read_b64_tr_b16 v[68:69], v82 offset:5376
  ds_read_b64_tr_b16 v[70:71], v82 offset:5760
  v_exp_f32 v24, v24
  v_exp_f32 v25, v25
  v_exp_f32 v26, v26
  v_exp_f32 v27, v27
  v_cvt_pk_bf16_f32 v52, v24, v25
  v_cvt_pk_bf16_f32 v53, v26, v27
  s_waitcnt lgkmcnt(0)
  v_mfma_f32_32x32x16_bf16 v[32:47], v[64:67], v[48:51], v[32:47]
  v_exp_f32 v28, v28
  v_exp_f32 v29, v29
  v_exp_f32 v30, v30
  v_exp_f32 v31, v31
  v_cvt_pk_bf16_f32 v54, v28, v29
  v_cvt_pk_bf16_f32 v55, v30, v31
  s_cmp_lg_u32 s29, 0
  s_cbranch_scc1 aq_go
  s_mov_b64 exec, 65535
  v_lshlrev_b32 v88, 2, v115
  s_mov_b32 s53, 0
aq_p:
  s_add_u32 s53, s53, 1
  s_cmp_ge_u32 s53, 0x100000
  s_cbranch_scc1 aq_e
  buffer_load_dword v89, v88, s[16:19], s83 offen offset:0 sc1
  s_waitcnt vmcnt(0)
  v_cmp_ne_u32 vcc, 1, v89
  s_cbranch_vccnz aq_p
aq_e:
  s_mov_b64 exec, -1
aq_go:
  s_barrier
  s_add_u32 s34, s34, 6144
  s_cmp_eq_u32 s34, s42
  s_cselect_b32 s34, s40, s34
  s_mov_b32 s36, 1
  s_branch at_pro
at_start:
  s_add_u32 s34, s38, 3145728
  s_movk_i32 s43, 64
  v_mov_b32 v86, 0xff800000
  v_mov_b32 v78, 0
  v_mov_b32 v79, 0
at_max:
  buffer_load_dwordx4 v[56:59], v84, s[16:19], s34 offen
  buffer_load_dwordx4 v[60:63], v85, s[16:19], s34 offen
  s_add_u32 s34, s34, 1536
  s_sub_u32 s43, s43, 1
  s_waitcnt vmcnt(0)
  v_mfma_f32_32x32x16_bf16 v[0:15], v[56:59], v[72:75], 0
  v_mfma_f32_32x32x16_bf16 v[0:15], v[60:63], v[76:79], v[0:15]
  s_nop 11
  v_max3_f32 v86, v86, v0, v1
  v_max3_f32 v86, v86, v2, v3
  v_max3_f32 v86, v86, v4, v5
  v_max3_f32 v86, v86, v6, v7
  v_max3_f32 v86, v86, v8, v9
  v_max3_f32 v86, v86, v10, v11
  v_max3_f32 v86, v86, v12, v13
  v_max3_f32 v86, v86, v14, v15
  s_cmp_lg_u32 s43, 0
  s_cbranch_scc1 at_max
  v_mov_b32 v88, v86
  s_nop 1
  v_permlane32_swap_b32 v86, v88
  v_max_f32 v86, v86, v88
  v_xor_b32 v86, 0x80000000, v86
  v_and_b32 v88, 0xffff0000, v86
  v_sub_f32 v86, v86, v88
  v_and_b32 v89, 0xffff0000, v86
  v_sub_f32 v86, v86, v89
  v_lshrrev_b32 v88, 16, v88
  v_or_b32 v88, v88, v89
  v_lshrrev_b32 v86, 16, v86
  v_cmp_gt_u32 vcc, 32, v115
  s_nop 1
  v_cndmask_b32 v78, 0, v88, vcc
  v_cndmask_b32 v79, 0, v86, vcc
  v_mov_b32 v32, 0
  v_mov_b32 v33, 0
  v_mov_b32 v34, 0
  v_mov_b32 v35, 0
  v_mov_b32 v36, 0
  v_mov_b32 v37, 0
  v_mov_b32 v38, 0
  v_mov_b32 v39, 0
  v_mov_b32 v40, 0
  v_mov_b32 v41, 0
  v_mov_b32 v42, 0
  v_mov_b32 v43, 0
  v_mov_b32 v44, 0
  v_mov_b32 v45, 0
  v_mov_b32 v46, 0
  v_mov_b32 v47, 0
  v_mov_b32 v52, 0
  v_mov_b32 v68, 0
  v_mov_b32 v53, 0
  v_mov_b32 v69, 0
  v_mov_b32 v54, 0
  v_mov_b32 v70, 0
  v_mov_b32 v55, 0
  v_mov_b32 v71, 0
  s_mov_b32 s34, s40
  s_add_u32 s42, s40, 98304
  s_mov_b32 s36, 0
at_pro:
  s_add_u32 s35, s41, 24576
  s_mov_b32 m0, s35
  s_nop 0
  buffer_load_dwordx4 v83, s[16:19], s34 offen offset:0 lds
  buffer_load_dwordx4 v83, s[16:19], s34 offen offset:1024 lds
  buffer_load_dwordx4 v83, s[16:19], s34 offen offset:2048 lds
  s_add_u32 s34, s34, 6144
  s_cmp_eq_u32 s34, s42
  s_cselect_b32 s34, s40, s34
  s_add_u32 s35, s35, 24576
  s_mov_b32 m0, s35
  s_nop 0
  buffer_load_dwordx4 v83, s[16:19], s34 offen offset:0 lds
  buffer_load_dwordx4 v83, s[16:19], s34 offen offset:1024 lds
  buffer_load_dwordx4 v83, s[16:19], s34 offen offset:2048 lds
  s_add_u32 s3, s30, 24576
  v_add_u32 v80, s3, v84
  v_add_u32 v81, s3, v85
  v_add_u32 v82, 24576, v87
  s_movk_i32 s82, 24576
  s_mov_b32 s80, 1
  s_mov_b32 s81, 0
  s_waitcnt vmcnt(3)
  s_barrier
  ds_read_b128 v[56:59], v80
  ds_read_b128 v[60:63], v81
  s_waitcnt lgkmcnt(0)
  v_mfma_f32_32x32x16_bf16 v[0:15], v[56:59], v[72:75], 0
  v_mfma_f32_32x32x16_bf16 v[0:15], v[60:63], v[76:79], v[0:15]
  ds_read_b128 v[56:59], v80 offset:1536
  ds_read_b128 v[60:63], v81 offset:1536
  s_waitcnt lgkmcnt(0)
at_loop:
  v_add_u32 v82, s81, v82
  s_waitcnt lgkmcnt(3)
  v_mfma_f32_32x32x16_bf16 v[16:31], v[56:59], v[72:75], 0
  ds_read_b64_tr_b16 v[64:65], v82 offset:0
  ds_read_b64_tr_b16 v[66:67], v82 offset:384
  s_nop 3
  v_exp_f32 v0, v0
  v_exp_f32 v1, v1
  v_exp_f32 v2, v2
  v_exp_f32 v3, v3
  v_cvt_pk_bf16_f32 v48, v0, v1
  v_cvt_pk_bf16_f32 v49, v2, v3
  s_waitcnt lgkmcnt(3)
  v_mfma_f32_32x32x16_bf16 v[32:47], v[68:71], v[52:55], v[32:47]
  ds_read_b128 v[56:59], v80 offset:3072
  v_exp_f32 v4, v4
  v_exp_f32 v5, v5
  v_exp_f32 v6, v6
  v_exp_f32 v7, v7
  v_cvt_pk_bf16_f32 v50, v4, v5
  v_cvt_pk_bf16_f32 v51, v6, v7
  s_waitcnt lgkmcnt(3)
  v_mfma_f32_32x32x16_bf16 v[16:31], v[60:63], v[76:79], v[16:31]
  ds_read_b64_tr_b16 v[68:69], v82 offset:768
  ds_read_b64_tr_b16 v[70:71], v82 offset:1152
  v_exp_f32 v8, v8
  v_exp_f32 v9, v9
  v_exp_f32 v10, v10
  v_exp_f32 v11, v11
  v_cvt_pk_bf16_f32 v52, v8, v9
  v_cvt_pk_bf16_f32 v53, v10, v11
  s_waitcnt lgkmcnt(3)
  v_mfma_f32_32x32x16_bf16 v[32:47], v[64:67], v[48:51], v[32:47]
  ds_read_b128 v[60:63], v81 offset:3072
  v_exp_f32 v12, v12
  v_exp_f32 v13, v13
  v_exp_f32 v14, v14
  v_exp_f32 v15, v15
  v_cvt_pk_bf16_f32 v54, v12, v13
  v_cvt_pk_bf16_f32 v55, v14, v15
  s_waitcnt lgkmcnt(3)
  v_mfma_f32_32x32x16_bf16 v[0:15], v[56:59], v[72:75], 0
  ds_read_b64_tr_b16 v[64:65], v82 offset:1536
  ds_read_b64_tr_b16 v[66:67], v82 offset:1920
  v_exp_f32 v16, v16
  v_exp_f32 v17, v17
  v_exp_f32 v18, v18
  v_exp_f32 v19, v19
  v_cvt_pk_bf16_f32 v48, v16, v17
  v_cvt_pk_bf16_f32 v49, v18, v19
  s_waitcnt lgkmcnt(3)
  v_mfma_f32_32x32x16_bf16 v[32:47], v[68:71], v[52:55], v[32:47]
  ds_read_b128 v[56:59], v80 offset:4608
  v_exp_f32 v20, v20
  v_exp_f32 v21, v21
  v_exp_f32 v22, v22
  v_exp_f32 v23, v23
  v_cvt_pk_bf16_f32 v50, v20, v21
  v_cvt_pk_bf16_f32 v51, v22, v23
  s_waitcnt lgkmcnt(3)
  v_mfma_f32_32x32x16_bf16 v[0:15], v[60:63], v[76:79], v[0:15]
  ds_read_b64_tr_b16 v[68:69], v82 offset:2304
  ds_read_b64_tr_b16 v[70:71], v82 offset:2688
  v_exp_f32 v24, v24
  v_exp_f32 v25, v25
  v_exp_f32 v26, v26
  v_exp_f32 v27, v27
  v_cvt_pk_bf16_f32 v52, v24, v25
  v_cvt_pk_bf16_f32 v53, v26, v27
  s_waitcnt lgkmcnt(3)
  v_mfma_f32_32x32x16_bf16 v[32:47], v[64:67], v[48:51], v[32:47]
  ds_read_b128 v[60:63], v81 offset:4608
  v_exp_f32 v28, v28
  v_exp_f32 v29, v29
  v_exp_f32 v30, v30
  v_exp_f32 v31, v31
  v_cvt_pk_bf16_f32 v54, v28, v29
  v_cvt_pk_bf16_f32 v55, v30, v31
  s_waitcnt lgkmcnt(3)
  v_mfma_f32_32x32x16_bf16 v[16:31], v[56:59], v[72:75], 0
  ds_read_b64_tr_b16 v[64:65], v82 offset:3072
  ds_read_b64_tr_b16 v[66:67], v82 offset:3456
  s_add_u32 s80, s80, 1
  s_cmp_eq_u32 s80, 3
  s_cselect_b32 s81, -49152, s82
  s_cselect_b32 s80, 0, s80
  v_add_u32 v80, s81, v80
  v_add_u32 v81, s81, v81
  s_add_u32 s34, s34, 6144
  s_cmp_eq_u32 s34, s42
  s_cselect_b32 s34, s40, s34
  s_add_u32 s35, s35, 24576
  s_cmp_eq_u32 s80, 2
  s_cselect_b32 s35, s41, s35
  v_exp_f32 v0, v0
  v_exp_f32 v1, v1
  v_exp_f32 v2, v2
  v_exp_f32 v3, v3
  v_cvt_pk_bf16_f32 v48, v0, v1
  v_cvt_pk_bf16_f32 v49, v2, v3
  s_waitcnt vmcnt(0)
  s_barrier
  s_cmp_ge_u32 s36, 14
  s_cbranch_scc1 at_nodma
  s_mov_b32 m0, s35
  s_nop 0
  buffer_load_dwordx4 v83, s[16:19], s34 offen offset:0 lds
  buffer_load_dwordx4 v83, s[16:19], s34 offen offset:1024 lds
  buffer_load_dwordx4 v83, s[16:19], s34 offen offset:2048 lds
at_nodma:
  s_waitcnt lgkmcnt(3)
  v_mfma_f32_32x32x16_bf16 v[32:47], v[68:71], v[52:55], v[32:47]
  ds_read_b128 v[56:59], v80 offset:0
  v_exp_f32 v4, v4
  v_exp_f32 v5, v5
  v_exp_f32 v6, v6
  v_exp_f32 v7, v7
  v_cvt_pk_bf16_f32 v50, v4, v5
  v_cvt_pk_bf16_f32 v51, v6, v7
  s_waitcnt lgkmcnt(3)
  v_mfma_f32_32x32x16_bf16 v[16:31], v[60:63], v[76:79], v[16:31]
  ds_read_b64_tr_b16 v[68:69], v82 offset:3840
  ds_read_b64_tr_b16 v[70:71], v82 offset:4224
  v_exp_f32 v8, v8
  v_exp_f32 v9, v9
  v_exp_f32 v10, v10
  v_exp_f32 v11, v11
  v_cvt_pk_bf16_f32 v52, v8, v9
  v_cvt_pk_bf16_f32 v53, v10, v11
  s_waitcnt lgkmcnt(3)
  v_mfma_f32_32x32x16_bf16 v[32:47], v[64:67], v[48:51], v[32:47]
  ds_read_b128 v[60:63], v81 offset:0
  v_exp_f32 v12, v12
  v_exp_f32 v13, v13
  v_exp_f32 v14, v14
  v_exp_f32 v15, v15
  v_cvt_pk_bf16_f32 v54, v12, v13
  v_cvt_pk_bf16_f32 v55, v14, v15
  s_waitcnt lgkmcnt(3)
  v_mfma_f32_32x32x16_bf16 v[0:15], v[56:59], v[72:75], 0
  ds_read_b64_tr_b16 v[64:65], v82 offset:4608
  ds_read_b64_tr_b16 v[66:67], v82 offset:4992
  v_exp_f32 v16, v16
  v_exp_f32 v17, v17
  v_exp_f32 v18, v18
  v_exp_f32 v19, v19
  v_cvt_pk_bf16_f32 v48, v16, v17
  v_cvt_pk_bf16_f32 v49, v18, v19
  s_waitcnt lgkmcnt(3)
  v_mfma_f32_32x32x16_bf16 v[32:47], v[68:71], v[52:55], v[32:47]
  ds_read_b128 v[56:59], v80 offset:1536
  v_exp_f32 v20, v20
  v_exp_f32 v21, v21
  v_exp_f32 v22, v22
  v_exp_f32 v23, v23
  v_cvt_pk_bf16_f32 v50, v20, v21
  v_cvt_pk_bf16_f32 v51, v22, v23
  s_waitcnt lgkmcnt(3)
  v_mfma_f32_32x32x16_bf16 v[0:15], v[60:63], v[76:79], v[0:15]
  ds_read_b64_tr_b16 v[68:69], v82 offset:5376
  ds_read_b64_tr_b16 v[70:71], v82 offset:5760
  v_exp_f32 v24, v24
  v_exp_f32 v25, v25
  v_exp_f32 v26, v26
  v_exp_f32 v27, v27
  v_cvt_pk_bf16_f32 v52, v24, v25
  v_cvt_pk_bf16_f32 v53, v26, v27
  s_waitcnt lgkmcnt(3)
  v_mfma_f32_32x32x16_bf16 v[32:47], v[64:67], v[48:51], v[32:47]
  ds_read_b128 v[60:63], v81 offset:1536
  v_exp_f32 v28, v28
  v_exp_f32 v29, v29
  v_exp_f32 v30, v30
  v_exp_f32 v31, v31
  v_cvt_pk_bf16_f32 v54, v28, v29
  v_cvt_pk_bf16_f32 v55, v30, v31
  s_add_u32 s36, s36, 1
  s_cmp_lt_u32 s36, 16
  s_cbranch_scc1 at_loop
  s_waitcnt lgkmcnt(0)
  v_mfma_f32_32x32x16_bf16 v[32:47], v[68:71], v[52:55], v[32:47]
  v_and_b32 v89, 31, v115
  v_lshlrev_b32 v88, 4, v115
  v_lshlrev_b32 v89, 4, v89
  v_lshrrev_b32 v90, 5, v115
  v_lshl_add_u32 v89, v90, 30, v89
  s_mul_i32 s3, s33, 2560
  s_add_u32 s42, s3, s31
  s_add_u32 s42, s42, 9437184
  s_lshl_b32 s3, s39, 3
  s_add_u32 s43, s42, s3
  s_mul_i32 s3, s39, 1536
  s_add_u32 s42, s42, s3
  v_mov_b32 v90, 1400897536
  v_mov_b32 v91, 73728
  v_mov_b32 v92, 1
  v_cmp_nlt_f32 vcc, v44, v90
  v_rcp_f32 v86, v44
  s_cbranch_vccz at_ok
  ds_write_b32 v91, v92
at_ok:
  v_mul_f32 v32, v86, v32
  v_mul_f32 v33, v86, v33
  v_cvt_pk_bf16_f32 v48, v32, v33
  v_mul_f32 v34, v86, v34
  v_mul_f32 v35, v86, v35
  v_cvt_pk_bf16_f32 v49, v34, v35
  v_mul_f32 v36, v86, v36
  v_mul_f32 v37, v86, v37
  v_cvt_pk_bf16_f32 v50, v36, v37
  v_mul_f32 v38, v86, v38
  v_mul_f32 v39, v86, v39
  v_cvt_pk_bf16_f32 v51, v38, v39
  v_mul_f32 v40, v86, v40
  v_mul_f32 v41, v86, v41
  v_cvt_pk_bf16_f32 v52, v40, v41
  v_mul_f32 v42, v86, v42
  v_mul_f32 v43, v86, v43
  v_cvt_pk_bf16_f32 v53, v42, v43
  buffer_store_dwordx4 v[48:51], v88, s[16:19], s42 offen sc1
  buffer_store_dwordx2 v[52:53], v89, s[16:19], s43 offen offset:1024 sc1
  s_setprio 2
  s_waitcnt vmcnt(0) lgkmcnt(0)
  s_barrier
  s_cmp_lg_u32 s37, 0
  s_cbranch_scc1 at_done
  ds_read_b32 v88, v91
  s_waitcnt lgkmcnt(0)
  v_readfirstlane_b32 s37, v88
  s_nop 1
  s_cmp_lg_u32 s37, 0
  s_cbranch_scc1 at_start
at_done:
  s_cmp_lg_u32 s29, 0
  s_cbranch_scc1 ao_s
  s_lshr_b32 s3, s32, 1
  s_and_b32 s52, s32, 1
  s_lshl_b32 s52, s52, 3
  s_or_b32 s3, s3, s52
  s_or_b32 s3, s3, 0
  v_lshlrev_b32 v88, 4, v115
  s_lshl_b32 s52, s33, 2
  v_or_b32 v88, s3, v88
  v_lshlrev_b32 v88, 9, v88
  v_mov_b32 v89, 1
  s_add_u32 s52, s52, 16400384
  s_mov_b64 exec, 0xffff
  buffer_store_dword v89, v88, s[16:19], s52 offen offset:128 sc1
  s_mov_b64 exec, -1
ao_s:
  s_mul_i32 s34, s55, 80
  s_lshl_b32 s35, s29, 10
  s_lshl_b32 s3, s29, 6
  v_add_u32 v0, s3, v115
  s_mov_b32 s36, 52429
  v_mul_u32_u24 v1, s36, v0
  v_lshrrev_b32 v1, 18, v1
  v_mul_u32_u24 v1, 1200, v1
  v_lshl_add_u32 v2, v0, 4, v1
  s_add_u32 m0, s35, 0
  v_add_u32 v0, 512, v0
  buffer_load_dwordx4 v2, s[56:59], s34 offen lds
  v_mul_u32_u24 v1, s36, v0
  v_lshrrev_b32 v1, 18, v1
  v_mul_u32_u24 v1, 1200, v1
  v_lshl_add_u32 v3, v0, 4, v1
  s_add_u32 m0, s35, 8192
  v_add_u32 v0, 512, v0
  buffer_load_dwordx4 v3, s[56:59], s34 offen lds
  v_mul_u32_u24 v1, s36, v0
  v_lshrrev_b32 v1, 18, v1
  v_mul_u32_u24 v1, 1200, v1
  v_lshl_add_u32 v4, v0, 4, v1
  s_add_u32 m0, s35, 16384
  v_add_u32 v0, 512, v0
  buffer_load_dwordx4 v4, s[56:59], s34 offen lds
  v_mul_u32_u24 v1, s36, v0
  v_lshrrev_b32 v1, 18, v1
  v_mul_u32_u24 v1, 1200, v1
  v_lshl_add_u32 v5, v0, 4, v1
  s_add_u32 m0, s35, 24576
  v_add_u32 v0, 512, v0
  buffer_load_dwordx4 v5, s[56:59], s34 offen lds
  v_mul_u32_u24 v1, s36, v0
  v_lshrrev_b32 v1, 18, v1
  v_mul_u32_u24 v1, 1200, v1
  v_lshl_add_u32 v6, v0, 4, v1
  s_add_u32 m0, s35, 32768
  v_add_u32 v0, 512, v0
  buffer_load_dwordx4 v6, s[56:59], s34 offen lds
  v_mul_u32_u24 v1, s36, v0
  v_lshrrev_b32 v1, 18, v1
  v_mul_u32_u24 v1, 1200, v1
  v_lshl_add_u32 v7, v0, 4, v1
  s_add_u32 m0, s35, 40960
  v_add_u32 v0, 512, v0
  buffer_load_dwordx4 v7, s[56:59], s34 offen lds
  s_cmp_ge_u32 s29, 2
  s_cbranch_scc1 f_nodA
  v_mul_u32_u24 v1, s36, v0
  v_lshrrev_b32 v1, 18, v1
  v_mul_u32_u24 v1, 1200, v1
  v_lshl_add_u32 v8, v0, 4, v1
  s_add_u32 m0, s35, 49152
  v_add_u32 v0, 512, v0
  buffer_load_dwordx4 v8, s[56:59], s34 offen lds
f_nodA:
  v_mov_b32 v127, v115
  v_bfe_u32 v0, v127, 2, 2
  v_lshrrev_b32 v1, 5, v127
  v_lshl_add_u32 v0, v1, 3, v0
  v_mul_u32_u24 v0, 80, v0
  s_mul_i32 s3, s39, 25600
  v_add_u32 v0, s3, v0
  v_and_b32 v1, 1, v127
  v_mul_u32_u24 v1, 40, v1
  v_add_u32 v0, v0, v1
  v_add_u32 v125, 32, v0
  v_bfe_u32 v1, v127, 1, 1
  v_bfe_u32 v16, v127, 4, 1
  v_lshl_add_u32 v1, v16, 1, v1
  v_lshl_add_u32 v124, v1, 3, v0
  v_lshlrev_b32 v126, 4, v127
  s_lshl_b32 s3, s54, 2
  s_and_b32 s36, s29, 3
  s_add_u32 s43, s3, s36
  s_mul_i32 s34, s43, 40960
  s_mul_i32 s3, s39, 20480
  s_add_u32 s34, s34, s3
  s_add_u32 s34, s34, 9437184
  s_waitcnt vmcnt(0)
  s_cmp_lg_u32 s29, 0
  s_cbranch_scc1 oA_go
  s_mov_b64 exec, 65535
  v_lshlrev_b32 v0, 2, v115
  s_mov_b32 s53, 0
oA_p:
  s_add_u32 s53, s53, 1
  s_cmp_ge_u32 s53, 0x100000
  s_cbranch_scc1 oA_e
  buffer_load_dword v1, v0, s[16:19], s83 offen offset:128 sc1
  s_waitcnt vmcnt(0)
  v_cmp_ne_u32 vcc, 1, v1
  s_cbranch_vccnz oA_p
oA_e:
  s_mov_b64 exec, -1
oA_go:
  s_barrier
  buffer_load_dwordx4 v[32:35], v126, s[16:19], s34 offen offset:0 sc1
  buffer_load_dwordx4 v[36:39], v126, s[16:19], s34 offen offset:1024 sc1
  buffer_load_dwordx4 v[40:43], v126, s[16:19], s34 offen offset:2048 sc1
  buffer_load_dwordx4 v[44:47], v126, s[16:19], s34 offen offset:3072 sc1
  s_add_u32 s34, s34, 4096
  buffer_load_dwordx4 v[48:51], v126, s[16:19], s34 offen offset:0 sc1
  buffer_load_dwordx4 v[52:55], v126, s[16:19], s34 offen offset:1024 sc1
  buffer_load_dwordx4 v[56:59], v126, s[16:19], s34 offen offset:2048 sc1
  buffer_load_dwordx4 v[60:63], v126, s[16:19], s34 offen offset:3072 sc1
  s_add_u32 s34, s34, 4096
  buffer_load_dwordx4 v[64:67], v126, s[16:19], s34 offen offset:0 sc1
  buffer_load_dwordx4 v[68:71], v126, s[16:19], s34 offen offset:1024 sc1
  buffer_load_dwordx4 v[72:75], v126, s[16:19], s34 offen offset:2048 sc1
  buffer_load_dwordx4 v[76:79], v126, s[16:19], s34 offen offset:3072 sc1
  s_add_u32 s34, s34, 4096
  buffer_load_dwordx4 v[80:83], v126, s[16:19], s34 offen offset:0 sc1
  buffer_load_dwordx4 v[84:87], v126, s[16:19], s34 offen offset:1024 sc1
  buffer_load_dwordx4 v[88:91], v126, s[16:19], s34 offen offset:2048 sc1
  buffer_load_dwordx4 v[92:95], v126, s[16:19], s34 offen offset:3072 sc1
  s_add_u32 s34, s34, 4096
  buffer_load_dwordx4 v[96:99], v126, s[16:19], s34 offen offset:0 sc1
  buffer_load_dwordx4 v[100:103], v126, s[16:19], s34 offen offset:1024 sc1
  buffer_load_dwordx4 v[104:107], v126, s[16:19], s34 offen offset:2048 sc1
  buffer_load_dwordx4 v[108:111], v126, s[16:19], s34 offen offset:3072 sc1
  s_add_u32 s34, s34, 4096
  ds_read_b64_tr_b16 v[112:113], v124 offset:0
  ds_read_b64_tr_b16 v[114:115], v124 offset:320
  ds_read_b64_tr_b16 v[116:117], v125 offset:0
  ds_read_b64_tr_b16 v[118:119], v125 offset:320
  ds_read_b64_tr_b16 v[120:121], v124 offset:1280
  ds_read_b64_tr_b16 v[122:123], v124 offset:1600
  s_waitcnt vmcnt(19) lgkmcnt(4)
  v_mfma_f32_32x32x16_bf16 v[0:15], v[112:115], v[32:35], 0
  ds_read_b64_tr_b16 v[112:113], v125 offset:1280
  ds_read_b64_tr_b16 v[114:115], v125 offset:1600
  s_waitcnt vmcnt(19) lgkmcnt(4)
  v_mfma_f32_32x32x16_bf16 v[16:31], v[116:119], v[32:35], 0
  ds_read_b64_tr_b16 v[116:117], v124 offset:2560
  ds_read_b64_tr_b16 v[118:119], v124 offset:2880
  s_waitcnt vmcnt(18) lgkmcnt(4)
  v_mfma_f32_32x32x16_bf16 v[0:15], v[120:123], v[36:39], v[0:15]
  ds_read_b64_tr_b16 v[120:121], v125 offset:2560
  ds_read_b64_tr_b16 v[122:123], v125 offset:2880
  s_waitcnt vmcnt(18) lgkmcnt(4)
  v_mfma_f32_32x32x16_bf16 v[16:31], v[112:115], v[36:39], v[16:31]
  ds_read_b64_tr_b16 v[112:113], v124 offset:3840
  ds_read_b64_tr_b16 v[114:115], v124 offset:4160
  s_waitcnt vmcnt(17) lgkmcnt(4)
  v_mfma_f32_32x32x16_bf16 v[0:15], v[116:119], v[40:43], v[0:15]
  ds_read_b64_tr_b16 v[116:117], v125 offset:3840
  ds_read_b64_tr_b16 v[118:119], v125 offset:4160
  s_waitcnt vmcnt(17) lgkmcnt(4)
  v_mfma_f32_32x32x16_bf16 v[16:31], v[120:123], v[40:43], v[16:31]
  ds_read_b64_tr_b16 v[120:121], v124 offset:5120
  ds_read_b64_tr_b16 v[122:123], v124 offset:5440
  s_waitcnt vmcnt(16) lgkmcnt(4)
  v_mfma_f32_32x32x16_bf16 v[0:15], v[112:115], v[44:47], v[0:15]
  ds_read_b64_tr_b16 v[112:113], v125 offset:5120
  ds_read_b64_tr_b16 v[114:115], v125 offset:5440
  s_waitcnt vmcnt(16) lgkmcnt(4)
  v_mfma_f32_32x32x16_bf16 v[16:31], v[116:119], v[44:47], v[16:31]
  ds_read_b64_tr_b16 v[116:117], v124 offset:6400
  ds_read_b64_tr_b16 v[118:119], v124 offset:6720
  s_waitcnt vmcnt(15) lgkmcnt(4)
  v_mfma_f32_32x32x16_bf16 v[0:15], v[120:123], v[48:51], v[0:15]
  ds_read_b64_tr_b16 v[120:121], v125 offset:6400
  ds_read_b64_tr_b16 v[122:123], v125 offset:6720
  s_waitcnt vmcnt(15) lgkmcnt(4)
  v_mfma_f32_32x32x16_bf16 v[16:31], v[112:115], v[48:51], v[16:31]
  ds_read_b64_tr_b16 v[112:113], v124 offset:7680
  ds_read_b64_tr_b16 v[114:115], v124 offset:8000
  s_waitcnt vmcnt(14) lgkmcnt(4)
  v_mfma_f32_32x32x16_bf16 v[0:15], v[116:119], v[52:55], v[0:15]
  ds_read_b64_tr_b16 v[116:117], v125 offset:7680
  ds_read_b64_tr_b16 v[118:119], v125 offset:8000
  s_waitcnt vmcnt(14) lgkmcnt(4)
  v_mfma_f32_32x32x16_bf16 v[16:31], v[120:123], v[52:55], v[16:31]
  ds_read_b64_tr_b16 v[120:121], v124 offset:8960
  ds_read_b64_tr_b16 v[122:123], v124 offset:9280
  s_waitcnt vmcnt(13) lgkmcnt(4)
  v_mfma_f32_32x32x16_bf16 v[0:15], v[112:115], v[56:59], v[0:15]
  ds_read_b64_tr_b16 v[112:113], v125 offset:8960
  ds_read_b64_tr_b16 v[114:115], v125 offset:9280
  s_waitcnt vmcnt(13) lgkmcnt(4)
  v_mfma_f32_32x32x16_bf16 v[16:31], v[116:119], v[56:59], v[16:31]
  ds_read_b64_tr_b16 v[116:117], v124 offset:10240
  ds_read_b64_tr_b16 v[118:119], v124 offset:10560
  s_waitcnt vmcnt(12) lgkmcnt(4)
  v_mfma_f32_32x32x16_bf16 v[0:15], v[120:123], v[60:63], v[0:15]
  ds_read_b64_tr_b16 v[120:121], v125 offset:10240
  ds_read_b64_tr_b16 v[122:123], v125 offset:10560
  s_waitcnt vmcnt(12) lgkmcnt(4)
  v_mfma_f32_32x32x16_bf16 v[16:31], v[112:115], v[60:63], v[16:31]
  ds_read_b64_tr_b16 v[112:113], v124 offset:11520
  ds_read_b64_tr_b16 v[114:115], v124 offset:11840
  s_waitcnt vmcnt(11) lgkmcnt(4)
  v_mfma_f32_32x32x16_bf16 v[0:15], v[116:119], v[64:67], v[0:15]
  ds_read_b64_tr_b16 v[116:117], v125 offset:11520
  ds_read_b64_tr_b16 v[118:119], v125 offset:11840
  s_waitcnt vmcnt(11) lgkmcnt(4)
  v_mfma_f32_32x32x16_bf16 v[16:31], v[120:123], v[64:67], v[16:31]
  ds_read_b64_tr_b16 v[120:121], v124 offset:12800
  ds_read_b64_tr_b16 v[122:123], v124 offset:13120
  s_waitcnt vmcnt(10) lgkmcnt(4)
  v_mfma_f32_32x32x16_bf16 v[0:15], v[112:115], v[68:71], v[0:15]
  ds_read_b64_tr_b16 v[112:113], v125 offset:12800
  ds_read_b64_tr_b16 v[114:115], v125 offset:13120
  s_waitcnt vmcnt(10) lgkmcnt(4)
  v_mfma_f32_32x32x16_bf16 v[16:31], v[116:119], v[68:71], v[16:31]
  ds_read_b64_tr_b16 v[116:117], v124 offset:14080
  ds_read_b64_tr_b16 v[118:119], v124 offset:14400
  s_waitcnt vmcnt(9) lgkmcnt(4)
  v_mfma_f32_32x32x16_bf16 v[0:15], v[120:123], v[72:75], v[0:15]
  ds_read_b64_tr_b16 v[120:121], v125 offset:14080
  ds_read_b64_tr_b16 v[122:123], v125 offset:14400
  s_waitcnt vmcnt(9) lgkmcnt(4)
  v_mfma_f32_32x32x16_bf16 v[16:31], v[112:115], v[72:75], v[16:31]
  ds_read_b64_tr_b16 v[112:113], v124 offset:15360
  ds_read_b64_tr_b16 v[114:115], v124 offset:15680
  s_waitcnt vmcnt(8) lgkmcnt(4)
  v_mfma_f32_32x32x16_bf16 v[0:15], v[116:119], v[76:79], v[0:15]
  ds_read_b64_tr_b16 v[116:117], v125 offset:15360
  ds_read_b64_tr_b16 v[118:119], v125 offset:15680
  s_waitcnt vmcnt(8) lgkmcnt(4)
  v_mfma_f32_32x32x16_bf16 v[16:31], v[120:123], v[76:79], v[16:31]
  ds_read_b64_tr_b16 v[120:121], v124 offset:16640
  ds_read_b64_tr_b16 v[122:123], v124 offset:16960
  s_waitcnt vmcnt(7) lgkmcnt(4)
  v_mfma_f32_32x32x16_bf16 v[0:15], v[112:115], v[80:83], v[0:15]
  ds_read_b64_tr_b16 v[112:113], v125 offset:16640
  ds_read_b64_tr_b16 v[114:115], v125 offset:16960
  s_waitcnt vmcnt(7) lgkmcnt(4)
  v_mfma_f32_32x32x16_bf16 v[16:31], v[116:119], v[80:83], v[16:31]
  ds_read_b64_tr_b16 v[116:117], v124 offset:17920
  ds_read_b64_tr_b16 v[118:119], v124 offset:18240
  s_waitcnt vmcnt(6) lgkmcnt(4)
  v_mfma_f32_32x32x16_bf16 v[0:15], v[120:123], v[84:87], v[0:15]
  ds_read_b64_tr_b16 v[120:121], v125 offset:17920
  ds_read_b64_tr_b16 v[122:123], v125 offset:18240
  s_waitcnt vmcnt(6) lgkmcnt(4)
  v_mfma_f32_32x32x16_bf16 v[16:31], v[112:115], v[84:87], v[16:31]
  ds_read_b64_tr_b16 v[112:113], v124 offset:19200
  ds_read_b64_tr_b16 v[114:115], v124 offset:19520
  s_waitcnt vmcnt(5) lgkmcnt(4)
  v_mfma_f32_32x32x16_bf16 v[0:15], v[116:119], v[88:91], v[0:15]
  ds_read_b64_tr_b16 v[116:117], v125 offset:19200
  ds_read_b64_tr_b16 v[118:119], v125 offset:19520
  s_waitcnt vmcnt(5) lgkmcnt(4)
  v_mfma_f32_32x32x16_bf16 v[16:31], v[120:123], v[88:91], v[16:31]
  ds_read_b64_tr_b16 v[120:121], v124 offset:20480
  ds_read_b64_tr_b16 v[122:123], v124 offset:20800
  s_waitcnt vmcnt(4) lgkmcnt(4)
  v_mfma_f32_32x32x16_bf16 v[0:15], v[112:115], v[92:95], v[0:15]
  ds_read_b64_tr_b16 v[112:113], v125 offset:20480
  ds_read_b64_tr_b16 v[114:115], v125 offset:20800
  s_waitcnt vmcnt(4) lgkmcnt(4)
  v_mfma_f32_32x32x16_bf16 v[16:31], v[116:119], v[92:95], v[16:31]
  ds_read_b64_tr_b16 v[116:117], v124 offset:21760
  ds_read_b64_tr_b16 v[118:119], v124 offset:22080
  s_waitcnt vmcnt(3) lgkmcnt(4)
  v_mfma_f32_32x32x16_bf16 v[0:15], v[120:123], v[96:99], v[0:15]
  ds_read_b64_tr_b16 v[120:121], v125 offset:21760
  ds_read_b64_tr_b16 v[122:123], v125 offset:22080
  s_waitcnt vmcnt(3) lgkmcnt(4)
  v_mfma_f32_32x32x16_bf16 v[16:31], v[112:115], v[96:99], v[16:31]
  ds_read_b64_tr_b16 v[112:113], v124 offset:23040
  ds_read_b64_tr_b16 v[114:115], v124 offset:23360
  s_waitcnt vmcnt(2) lgkmcnt(4)
  v_mfma_f32_32x32x16_bf16 v[0:15], v[116:119], v[100:103], v[0:15]
  ds_read_b64_tr_b16 v[116:117], v125 offset:23040
  ds_read_b64_tr_b16 v[118:119], v125 offset:23360
  s_waitcnt vmcnt(2) lgkmcnt(4)
  v_mfma_f32_32x32x16_bf16 v[16:31], v[120:123], v[100:103], v[16:31]
  ds_read_b64_tr_b16 v[120:121], v124 offset:24320
  ds_read_b64_tr_b16 v[122:123], v124 offset:24640
  s_waitcnt vmcnt(1) lgkmcnt(4)
  v_mfma_f32_32x32x16_bf16 v[0:15], v[112:115], v[104:107], v[0:15]
  ds_read_b64_tr_b16 v[112:113], v125 offset:24320
  ds_read_b64_tr_b16 v[114:115], v125 offset:24640
  s_waitcnt vmcnt(1) lgkmcnt(4)
  v_mfma_f32_32x32x16_bf16 v[16:31], v[116:119], v[104:107], v[16:31]
  s_waitcnt vmcnt(0) lgkmcnt(2)
  v_mfma_f32_32x32x16_bf16 v[0:15], v[120:123], v[108:111], v[0:15]
  s_waitcnt vmcnt(0) lgkmcnt(0)
  v_mfma_f32_32x32x16_bf16 v[16:31], v[112:115], v[108:111], v[16:31]
  s_mul_i32 s3, s36, 5120
  s_add_u32 s3, s3, 51200
  v_add_u32 v126, s3, v126
  s_cmp_eq_u32 s39, 0
  s_cbranch_scc1 f_lo
  s_nop 4
  ds_write_b128 v126, v[0:3] offset:0
  ds_write_b128 v126, v[4:7] offset:1024
  ds_write_b128 v126, v[8:11] offset:2048
  ds_write_b128 v126, v[12:15] offset:3072
  ds_write_b128 v126, v[16:19] offset:4096
  s_waitcnt lgkmcnt(0)
  s_barrier
  s_endpgm
f_lo:
  s_barrier
  ds_read_b128 v[32:35], v126 offset:0
  ds_read_b128 v[36:39], v126 offset:1024
  ds_read_b128 v[40:43], v126 offset:2048
  ds_read_b128 v[44:47], v126 offset:3072
  ds_read_b128 v[48:51], v126 offset:4096
  v_and_b32 v60, 31, v127
  v_lshrrev_b32 v61, 5, v127
  v_mul_u32_u24 v60, 2560, v60
  v_mad_u32_u24 v60, v61, 40, v60
  s_mul_i32 s3, s43, 81920
  s_mul_i32 s34, s55, 80
  s_add_u32 s3, s3, s34
  s_add_u32 s3, s3, 0
  s_waitcnt lgkmcnt(4)
  v_add_f32 v0, v0, v32
  v_add_f32 v1, v1, v33
  v_cvt_pk_bf16_f32 v64, v0, v1
  s_waitcnt lgkmcnt(4)
  v_add_f32 v2, v2, v34
  v_add_f32 v3, v3, v35
  v_cvt_pk_bf16_f32 v65, v2, v3
  s_waitcnt lgkmcnt(3)
  v_add_f32 v4, v4, v36
  v_add_f32 v5, v5, v37
  v_cvt_pk_bf16_f32 v66, v4, v5
  s_waitcnt lgkmcnt(3)
  v_add_f32 v6, v6, v38
  v_add_f32 v7, v7, v39
  v_cvt_pk_bf16_f32 v67, v6, v7
  s_waitcnt lgkmcnt(2)
  v_add_f32 v8, v8, v40
  v_add_f32 v9, v9, v41
  v_cvt_pk_bf16_f32 v68, v8, v9
  s_waitcnt lgkmcnt(2)
  v_add_f32 v10, v10, v42
  v_add_f32 v11, v11, v43
  v_cvt_pk_bf16_f32 v69, v10, v11
  s_waitcnt lgkmcnt(1)
  v_add_f32 v12, v12, v44
  v_add_f32 v13, v13, v45
  v_cvt_pk_bf16_f32 v70, v12, v13
  s_waitcnt lgkmcnt(1)
  v_add_f32 v14, v14, v46
  v_add_f32 v15, v15, v47
  v_cvt_pk_bf16_f32 v71, v14, v15
  s_waitcnt lgkmcnt(0)
  v_add_f32 v16, v16, v48
  v_add_f32 v17, v17, v49
  v_cvt_pk_bf16_f32 v72, v16, v17
  s_waitcnt lgkmcnt(0)
  v_add_f32 v18, v18, v50
  v_add_f32 v19, v19, v51
  v_cvt_pk_bf16_f32 v73, v18, v19
  buffer_store_dwordx4 v[64:67], v60, s[60:63], s3 offen
  buffer_store_dwordx4 v[68:71], v60, s[60:63], s3 offen offset:16
  buffer_store_dwordx2 v[72:73], v60, s[60:63], s3 offen offset:32
  s_endpgm
k2_b:
  s_cmp_ge_u32 s29, 4
  s_cbranch_scc1 k2_end
  s_load_dwordx2 s[84:85], s[0:1], 16
  s_load_dwordx4 s[4:7], s[0:1], 24
  s_load_dwordx4 s[36:39], s[0:1], 40
  s_load_dwordx2 s[30:31], s[0:1], 56
  s_load_dwordx4 s[48:51], s[0:1], 64
  s_setprio 0
  s_and_b32 s3, s2, 3
  s_lshl_b32 s3, s3, 2
  s_bfe_u32 s33, s2, 0x20003
  s_add_u32 s33, s33, s3
  s_bfe_u32 s3, s2, 0x10002
  s_lshl_b32 s3, s3, 3
  s_bfe_u32 s32, s2, 0x30005
  s_add_u32 s32, s32, s3
  s_and_b32 s3, s2, 7
  s_lshl_b32 s3, s3, 1
  s_bfe_u32 s54, s2, 0x10003
  s_add_u32 s54, s54, s3
  s_bfe_u32 s55, s2, 0x40004
  s_mul_i32 s24, s33, 80
  s_mul_i32 s25, s32, 163840
  s_waitcnt lgkmcnt(0)
  s_mov_b32 s8, s6
  s_mov_b32 s9, s7
  s_mov_b32 s10, 2457600
  s_mov_b32 s11, 0x20000
  s_mov_b32 s12, s4
  s_mov_b32 s13, s5
  s_mov_b32 s14, 2621440
  s_mov_b32 s15, 0x20000
  s_mov_b32 s16, s50
  s_mov_b32 s17, s51
  s_mov_b32 s18, 16695296
  s_mov_b32 s19, 0x20000
  s_mov_b32 s40, s36
  s_mov_b32 s41, s37
  s_mov_b32 s42, 25600
  s_mov_b32 s43, 0x20000
  s_mov_b32 s44, s48
  s_mov_b32 s45, s49
  s_mov_b32 s46, 256
  s_mov_b32 s47, 0x20000
  s_mov_b32 s56, s38
  s_mov_b32 s57, s39
  s_mov_b32 s58, 819200
  s_mov_b32 s59, 0x20000
  s_mov_b32 s84, s84
  s_mov_b32 s85, s85
  s_mov_b32 s86, 819200
  s_mov_b32 s87, 0x20000
  s_mov_b32 s60, s30
  s_mov_b32 s61, s31
  s_mov_b32 s62, 5242880
  s_mov_b32 s63, 0x20000
  s_xor_b32 s33, s33, 1
  s_mul_i32 s24, s33, 80
  s_lshl_b32 s83, s2, 9
  s_add_u32 s83, s83, 16400384
  v_lshlrev_b32 v4, 3, v115
  v_mov_b32 v6, 0
  v_mov_b32 v7, 0
  s_cmp_lg_u32 s29, 0
  s_cbranch_scc1 fi4
  s_sub_u32 s3, s83, 131072
  buffer_store_dwordx2 v[6:7], v4, s[16:19], s83 offen sc1
  buffer_store_dwordx2 v[6:7], v4, s[16:19], s3 offen sc1
fi4:
  s_waitcnt vmcnt(0)
  s_cmp_lg_u32 s29, 0
  s_cbranch_scc1 b_fr
  v_mov_b32 v127, 1
  s_mov_b64 exec, 1
  buffer_atomic_add v127, off, s[44:47], 0 offset:128 sc1
  s_mov_b64 exec, -1
b_fr:
  s_cmp_lg_u32 s29, 0
  s_cbranch_scc1 bg1_go
  s_mov_b64 exec, 1
  v_lshlrev_b32 v116, 2, v115
  s_mov_b32 s53, 0
bg1_p:
  s_add_u32 s53, s53, 1
  s_cmp_ge_u32 s53, 0x100000
  s_cbranch_scc1 bg1_e
  buffer_load_dword v117, v116, s[16:19], s83 offen offset:256 sc1
  s_waitcnt vmcnt(0)
  v_cmp_gt_u32 vcc, 1, v117
  s_cbranch_vccnz bg1_p
bg1_e:
  s_mov_b64 exec, -1
bg1_go:
  s_barrier
  v_lshrrev_b32 v119, 4, v115
  v_lshlrev_b32 v118, 2, v119
  v_xor_b32 v118, v118, v115
  v_and_b32 v118, 15, v118
  s_mov_b32 s20, 2326024272
  s_mov_b32 s21, 0
  v_mul_u32_u24 v112, 2, v118
  v_lshrrev_b64 v[116:117], v112, s[20:21]
  v_and_b32 v112, 3, v116
  v_mul_u32_u24 v112, 1280, v112
  s_mov_b32 s20, 1684283424
  s_mov_b32 s21, 1619148936
  v_mul_u32_u24 v113, 4, v118
  v_lshrrev_b64 v[116:117], v113, s[20:21]
  v_and_b32 v113, 15, v116
  v_lshl_add_u32 v112, v113, 3, v112
  s_mov_b32 s27, 3840
  v_mad_u32_u24 v112, v119, s27, v112
  v_and_b32 v116, 7, v115
  v_xor_b32 v116, v116, v119
  v_lshrrev_b32 v118, 3, v115
  v_mul_u32_u24 v118, 1280, v118
  v_lshl_add_u32 v113, v116, 4, v118
  v_xor_b32 v114, 64, v113
  s_mul_i32 s27, s29, 30720
  s_add_u32 s24, s24, s27
  s_mul_i32 s27, s29, 40960
  s_add_u32 s25, s25, s27
  s_mul_i32 s26, s29, 4096
  s_lshr_b32 s22, s26, 1
  s_add_u32 m0, s26, 16384
  s_add_u32 s28, s25, 0
  buffer_load_dwordx4 v113, s[12:15], s28 offen  lds
  s_add_u32 m0, s26, 17408
  s_add_u32 s28, s25, 10240
  buffer_load_dwordx4 v114, s[12:15], s28 offen  lds
  s_add_u32 m0, s26, 18432
  s_add_u32 s28, s25, 20480
  buffer_load_dwordx4 v113, s[12:15], s28 offen  lds
  s_add_u32 m0, s26, 19456
  s_add_u32 s28, s25, 30720
  buffer_load_dwordx4 v114, s[12:15], s28 offen  lds
  s_add_u32 m0, s22, 0
  s_add_u32 s27, s24, 0
  buffer_load_dwordx4 v112, s[8:11], s27 offen  lds
  s_add_u32 m0, s22, 1024
  s_add_u32 s27, s24, 15360
  buffer_load_dwordx4 v112, s[8:11], s27 offen  lds
  s_add_u32 m0, s22, 8192
  s_add_u32 s27, s24, 122880
  buffer_load_dwordx4 v112, s[8:11], s27 offen  lds
  s_add_u32 m0, s22, 9216
  s_add_u32 s27, s24, 138240
  buffer_load_dwordx4 v112, s[8:11], s27 offen  lds
  s_add_u32 m0, s26, 49152
  s_add_u32 s28, s25, 128
  buffer_load_dwordx4 v113, s[12:15], s28 offen  lds
  s_add_u32 m0, s26, 50176
  s_add_u32 s28, s25, 10368
  buffer_load_dwordx4 v114, s[12:15], s28 offen  lds
  s_add_u32 m0, s26, 51200
  s_add_u32 s28, s25, 20608
  buffer_load_dwordx4 v113, s[12:15], s28 offen  lds
  s_add_u32 m0, s26, 52224
  s_add_u32 s28, s25, 30848
  buffer_load_dwordx4 v114, s[12:15], s28 offen  lds
  s_add_u32 m0, s22, 32768
  s_add_u32 s27, s24, 245760
  buffer_load_dwordx4 v112, s[8:11], s27 offen  lds
  s_add_u32 m0, s22, 33792
  s_add_u32 s27, s24, 261120
  buffer_load_dwordx4 v112, s[8:11], s27 offen  lds
  s_add_u32 m0, s22, 40960
  s_add_u32 s27, s24, 368640
  buffer_load_dwordx4 v112, s[8:11], s27 offen  lds
  s_add_u32 m0, s22, 41984
  s_add_u32 s27, s24, 384000
  buffer_load_dwordx4 v112, s[8:11], s27 offen  lds
  s_and_b32 s3, s29, 1
  s_lshl_b32 s3, s3, 10
  s_add_u32 m0, s3, 65536
  s_mul_i32 s34, s33, 1600
  s_add_u32 s34, s34, s3
  v_lshlrev_b32 v116, 4, v115
  buffer_load_dwordx4 v116, s[40:43], s34 offen lds
  s_lshl_b32 s3, s29, 9
  s_add_u32 s3, s3, 67584
  v_lshl_add_u32 v117, v115, 3, s3
  v_mov_b32 v118, 0
  v_mov_b32 v119, 0
  ds_write_b64 v117, v[118:119]
  s_lshl_b32 s3, s29, 6
  v_add_u32 v116, s3, v115
  s_bfe_u32 s34, s2, 0x20003
  s_mul_i32 s35, s34, 40960
  s_mul_i32 s3, s32, 163840
  s_add_u32 s35, s35, s3
  v_add_u32 v117, 0, v116
  v_min_u32 v117, 319, v117
  v_lshlrev_b32 v117, 7, v117
  buffer_load_dword v124, v117, s[12:15], s35 offen
  v_add_u32 v117, 256, v116
  v_min_u32 v117, 319, v117
  v_lshlrev_b32 v117, 7, v117
  buffer_load_dword v125, v117, s[12:15], s35 offen
  s_bfe_u32 s3, s2, 0x30005
  s_lshl_b32 s3, s3, 2
  s_add_u32 s3, s3, s34
  s_mul_i32 s35, s3, 76800
  s_and_b32 s3, s2, 3
  s_mul_i32 s3, s3, 320
  s_add_u32 s35, s35, s3
  v_min_u32 v116, 239, v116
  v_lshrrev_b32 v117, 2, v116
  v_and_b32 v116, 3, v116
  v_mul_u32_u24 v117, 1280, v117
  v_mul_u32_u24 v116, 104, v116
  v_add_u32 v116, v116, v117
  buffer_load_dword v126, v116, s[8:11], s35 offen
  v_lshrrev_b32 v118, 2, v115
  v_and_b32 v119, 3, v118
  v_and_b32 v118, 4, v118
  v_and_b32 v116, 3, v115
  v_or_b32 v120, v118, v116
  v_lshrrev_b32 v118, 5, v115
  v_lshl_add_u32 v118, v118, 3, v119
  v_lshlrev_b32 v121, 8, v118
  v_lshlrev_b32 v119, 3, v119
  s_mov_b32 s20, 83952640
  s_mov_b32 s21, 117638658
  v_mul_u32_u24 v104, 8, v120
  v_lshrrev_b64 v[116:117], v104, s[20:21]
  v_and_b32 v104, 255, v116
  v_xor_b32 v104, v104, v119
  v_lshl_add_u32 v104, v104, 3, v121
  s_mov_b32 s20, 218696712
  s_mov_b32 s21, 252382730
  v_mul_u32_u24 v105, 8, v120
  v_lshrrev_b64 v[116:117], v105, s[20:21]
  v_and_b32 v105, 255, v116
  v_xor_b32 v105, v105, v119
  v_lshl_add_u32 v105, v105, 3, v121
  s_mov_b32 s20, 319885840
  s_mov_b32 s21, 504698644
  v_mul_u32_u24 v106, 8, v120
  v_lshrrev_b64 v[116:117], v106, s[20:21]
  v_and_b32 v106, 255, v116
  v_xor_b32 v106, v106, v119
  v_lshl_add_u32 v106, v106, 3, v121
  s_mov_b32 s20, 437853976
  s_mov_b32 s21, 488381206
  v_mul_u32_u24 v107, 8, v120
  v_lshrrev_b64 v[116:117], v107, s[20:21]
  v_and_b32 v107, 255, v116
  v_xor_b32 v107, v107, v119
  v_lshl_add_u32 v107, v107, 3, v121
  v_and_b32 v116, 31, v115
  v_lshlrev_b32 v116, 7, v116
  v_lshrrev_b32 v118, 1, v115
  v_and_b32 v118, 7, v118
  v_lshrrev_b32 v119, 5, v115
  v_xor_b32 v118, v118, v119
  v_lshl_add_u32 v116, v118, 4, v116
  s_and_b32 s27, s29, 3
  s_lshl_b32 s27, s27, 12
  s_add_u32 s27, s27, 16384
  v_add_u32 v108, s27, v116
  v_xor_b32 v109, 32, v108
  v_xor_b32 v110, 64, v108
  v_xor_b32 v111, 96, v108
  s_waitcnt vmcnt(14)
  s_barrier
  ds_read_b128 v[96:99], v108 offset:0
  ds_read_b64_tr_b16 v[64:65], v104 offset:0
  ds_read_b64_tr_b16 v[66:67], v104 offset:1024
  ds_read_b64_tr_b16 v[68:69], v105 offset:0
  ds_read_b64_tr_b16 v[70:71], v105 offset:1024
  ds_read_b64_tr_b16 v[72:73], v106 offset:0
  ds_read_b64_tr_b16 v[74:75], v106 offset:1024
  ds_read_b64_tr_b16 v[76:77], v107 offset:0
  ds_read_b64_tr_b16 v[78:79], v107 offset:1024
  s_waitcnt lgkmcnt(6)
  v_mfma_f32_32x32x16_bf16 v[0:15], v[64:67], v[96:99], 0
  ds_read_b128 v[100:103], v109 offset:0
  ds_read_b64_tr_b16 v[80:81], v104 offset:4096
  ds_read_b64_tr_b16 v[82:83], v104 offset:5120
  ds_read_b64_tr_b16 v[84:85], v105 offset:4096
  ds_read_b64_tr_b16 v[86:87], v105 offset:5120
  ds_read_b64_tr_b16 v[88:89], v106 offset:4096
  ds_read_b64_tr_b16 v[90:91], v106 offset:5120
  ds_read_b64_tr_b16 v[92:93], v107 offset:4096
  ds_read_b64_tr_b16 v[94:95], v107 offset:5120
  ds_read_b128 v[116:119], v110 offset:0
  ds_read_b128 v[120:123], v111 offset:0
  s_waitcnt lgkmcnt(15)
  v_mfma_f32_32x32x16_bf16 v[16:31], v[68:71], v[96:99], 0
  s_waitcnt lgkmcnt(13)
  v_mfma_f32_32x32x16_bf16 v[32:47], v[72:75], v[96:99], 0
  s_waitcnt lgkmcnt(11)
  v_mfma_f32_32x32x16_bf16 v[48:63], v[76:79], v[96:99], 0
  s_waitcnt lgkmcnt(8)
  v_mfma_f32_32x32x16_bf16 v[0:15], v[80:83], v[100:103], v[0:15]
  s_waitcnt vmcnt(12) lgkmcnt(0)
  s_barrier
  ds_read_b64_tr_b16 v[64:65], v104 offset:8192
  ds_read_b64_tr_b16 v[66:67], v104 offset:9216
  ds_read_b64_tr_b16 v[68:69], v105 offset:8192
  ds_read_b64_tr_b16 v[70:71], v105 offset:9216
  ds_read_b64_tr_b16 v[72:73], v106 offset:8192
  ds_read_b64_tr_b16 v[74:75], v106 offset:9216
  ds_read_b64_tr_b16 v[76:77], v107 offset:8192
  ds_read_b64_tr_b16 v[78:79], v107 offset:9216
  v_mfma_f32_32x32x16_bf16 v[16:31], v[84:87], v[100:103], v[16:31]
  s_add_u32 m0, s22, 0
  s_add_u32 s27, s24, 491520
  buffer_load_dwordx4 v112, s[8:11], s27 offen  lds
  s_add_u32 m0, s22, 1024
  s_add_u32 s27, s24, 506880
  buffer_load_dwordx4 v112, s[8:11], s27 offen  lds
  v_mfma_f32_32x32x16_bf16 v[32:47], v[88:91], v[100:103], v[32:47]
  s_add_u32 m0, s26, 16384
  s_add_u32 s28, s25, 256
  buffer_load_dwordx4 v113, s[12:15], s28 offen  lds
  s_add_u32 m0, s26, 17408
  s_add_u32 s28, s25, 10496
  buffer_load_dwordx4 v114, s[12:15], s28 offen  lds
  v_mfma_f32_32x32x16_bf16 v[48:63], v[92:95], v[100:103], v[48:63]
  s_add_u32 m0, s26, 18432
  s_add_u32 s28, s25, 20736
  buffer_load_dwordx4 v113, s[12:15], s28 offen  lds
  s_add_u32 m0, s26, 19456
  s_add_u32 s28, s25, 30976
  buffer_load_dwordx4 v114, s[12:15], s28 offen  lds
  s_waitcnt lgkmcnt(6)
  v_mfma_f32_32x32x16_bf16 v[0:15], v[64:67], v[116:119], v[0:15]
  ds_read_b64_tr_b16 v[80:81], v104 offset:12288
  ds_read_b64_tr_b16 v[82:83], v104 offset:13312
  ds_read_b64_tr_b16 v[84:85], v105 offset:12288
  ds_read_b64_tr_b16 v[86:87], v105 offset:13312
  ds_read_b64_tr_b16 v[88:89], v106 offset:12288
  ds_read_b64_tr_b16 v[90:91], v106 offset:13312
  ds_read_b64_tr_b16 v[92:93], v107 offset:12288
  ds_read_b64_tr_b16 v[94:95], v107 offset:13312
  s_waitcnt lgkmcnt(12)
  v_mfma_f32_32x32x16_bf16 v[16:31], v[68:71], v[116:119], v[16:31]
  s_waitcnt lgkmcnt(10)
  v_mfma_f32_32x32x16_bf16 v[32:47], v[72:75], v[116:119], v[32:47]
  s_waitcnt lgkmcnt(8)
  v_mfma_f32_32x32x16_bf16 v[48:63], v[76:79], v[116:119], v[48:63]
  s_waitcnt lgkmcnt(6)
  v_mfma_f32_32x32x16_bf16 v[0:15], v[80:83], v[120:123], v[0:15]
  s_waitcnt vmcnt(12) lgkmcnt(0)
  s_barrier
  ds_read_b128 v[96:99], v108 offset:32768
  ds_read_b64_tr_b16 v[64:65], v104 offset:32768
  ds_read_b64_tr_b16 v[66:67], v104 offset:33792
  ds_read_b64_tr_b16 v[68:69], v105 offset:32768
  ds_read_b64_tr_b16 v[70:71], v105 offset:33792
  ds_read_b64_tr_b16 v[72:73], v106 offset:32768
  ds_read_b64_tr_b16 v[74:75], v106 offset:33792
  ds_read_b64_tr_b16 v[76:77], v107 offset:32768
  ds_read_b64_tr_b16 v[78:79], v107 offset:33792
  v_mfma_f32_32x32x16_bf16 v[16:31], v[84:87], v[120:123], v[16:31]
  s_add_u32 m0, s22, 8192
  s_add_u32 s27, s24, 614400
  buffer_load_dwordx4 v112, s[8:11], s27 offen  lds
  v_mfma_f32_32x32x16_bf16 v[32:47], v[88:91], v[120:123], v[32:47]
  s_add_u32 m0, s22, 9216
  s_add_u32 s27, s24, 629760
  buffer_load_dwordx4 v112, s[8:11], s27 offen  lds
  v_mfma_f32_32x32x16_bf16 v[48:63], v[92:95], v[120:123], v[48:63]
  s_waitcnt lgkmcnt(6)
  v_mfma_f32_32x32x16_bf16 v[0:15], v[64:67], v[96:99], v[0:15]
  ds_read_b128 v[100:103], v109 offset:32768
  ds_read_b64_tr_b16 v[80:81], v104 offset:36864
  ds_read_b64_tr_b16 v[82:83], v104 offset:37888
  ds_read_b64_tr_b16 v[84:85], v105 offset:36864
  ds_read_b64_tr_b16 v[86:87], v105 offset:37888
  ds_read_b64_tr_b16 v[88:89], v106 offset:36864
  ds_read_b64_tr_b16 v[90:91], v106 offset:37888
  ds_read_b64_tr_b16 v[92:93], v107 offset:36864
  ds_read_b64_tr_b16 v[94:95], v107 offset:37888
  ds_read_b128 v[116:119], v110 offset:32768
  ds_read_b128 v[120:123], v111 offset:32768
  s_waitcnt lgkmcnt(15)
  v_mfma_f32_32x32x16_bf16 v[16:31], v[68:71], v[96:99], v[16:31]
  s_waitcnt lgkmcnt(13)
  v_mfma_f32_32x32x16_bf16 v[32:47], v[72:75], v[96:99], v[32:47]
  s_waitcnt lgkmcnt(11)
  v_mfma_f32_32x32x16_bf16 v[48:63], v[76:79], v[96:99], v[48:63]
  s_waitcnt lgkmcnt(8)
  v_mfma_f32_32x32x16_bf16 v[0:15], v[80:83], v[100:103], v[0:15]
  s_waitcnt vmcnt(12) lgkmcnt(0)
  s_barrier
  ds_read_b64_tr_b16 v[64:65], v104 offset:40960
  ds_read_b64_tr_b16 v[66:67], v104 offset:41984
  ds_read_b64_tr_b16 v[68:69], v105 offset:40960
  ds_read_b64_tr_b16 v[70:71], v105 offset:41984
  ds_read_b64_tr_b16 v[72:73], v106 offset:40960
  ds_read_b64_tr_b16 v[74:75], v106 offset:41984
  ds_read_b64_tr_b16 v[76:77], v107 offset:40960
  ds_read_b64_tr_b16 v[78:79], v107 offset:41984
  v_mfma_f32_32x32x16_bf16 v[16:31], v[84:87], v[100:103], v[16:31]
  s_add_u32 m0, s22, 32768
  s_add_u32 s27, s24, 737280
  buffer_load_dwordx4 v112, s[8:11], s27 offen  lds
  s_add_u32 m0, s22, 33792
  s_add_u32 s27, s24, 752640
  buffer_load_dwordx4 v112, s[8:11], s27 offen  lds
  v_mfma_f32_32x32x16_bf16 v[32:47], v[88:91], v[100:103], v[32:47]
  s_add_u32 m0, s26, 49152
  s_add_u32 s28, s25, 384
  buffer_load_dwordx4 v113, s[12:15], s28 offen  lds
  s_add_u32 m0, s26, 50176
  s_add_u32 s28, s25, 10624
  buffer_load_dwordx4 v114, s[12:15], s28 offen  lds
  v_mfma_f32_32x32x16_bf16 v[48:63], v[92:95], v[100:103], v[48:63]
  s_add_u32 m0, s26, 51200
  s_add_u32 s28, s25, 20864
  buffer_load_dwordx4 v113, s[12:15], s28 offen  lds
  s_add_u32 m0, s26, 52224
  s_add_u32 s28, s25, 31104
  buffer_load_dwordx4 v114, s[12:15], s28 offen  lds
  s_waitcnt lgkmcnt(6)
  v_mfma_f32_32x32x16_bf16 v[0:15], v[64:67], v[116:119], v[0:15]
  ds_read_b64_tr_b16 v[80:81], v104 offset:45056
  ds_read_b64_tr_b16 v[82:83], v104 offset:46080
  ds_read_b64_tr_b16 v[84:85], v105 offset:45056
  ds_read_b64_tr_b16 v[86:87], v105 offset:46080
  ds_read_b64_tr_b16 v[88:89], v106 offset:45056
  ds_read_b64_tr_b16 v[90:91], v106 offset:46080
  ds_read_b64_tr_b16 v[92:93], v107 offset:45056
  ds_read_b64_tr_b16 v[94:95], v107 offset:46080
  s_waitcnt lgkmcnt(12)
  v_mfma_f32_32x32x16_bf16 v[16:31], v[68:71], v[116:119], v[16:31]
  s_waitcnt lgkmcnt(10)
  v_mfma_f32_32x32x16_bf16 v[32:47], v[72:75], v[116:119], v[32:47]
  s_waitcnt lgkmcnt(8)
  v_mfma_f32_32x32x16_bf16 v[48:63], v[76:79], v[116:119], v[48:63]
  s_waitcnt lgkmcnt(6)
  v_mfma_f32_32x32x16_bf16 v[0:15], v[80:83], v[120:123], v[0:15]
  s_waitcnt vmcnt(8) lgkmcnt(0)
  s_barrier
  ds_read_b128 v[96:99], v108 offset:0
  ds_read_b64_tr_b16 v[64:65], v104 offset:0
  ds_read_b64_tr_b16 v[66:67], v104 offset:1024
  ds_read_b64_tr_b16 v[68:69], v105 offset:0
  ds_read_b64_tr_b16 v[70:71], v105 offset:1024
  ds_read_b64_tr_b16 v[72:73], v106 offset:0
  ds_read_b64_tr_b16 v[74:75], v106 offset:1024
  ds_read_b64_tr_b16 v[76:77], v107 offset:0
  ds_read_b64_tr_b16 v[78:79], v107 offset:1024
  v_mfma_f32_32x32x16_bf16 v[16:31], v[84:87], v[120:123], v[16:31]
  s_add_u32 m0, s22, 40960
  s_add_u32 s27, s24, 860160
  buffer_load_dwordx4 v112, s[8:11], s27 offen  lds
  v_mfma_f32_32x32x16_bf16 v[32:47], v[88:91], v[120:123], v[32:47]
  s_add_u32 m0, s22, 41984
  s_add_u32 s27, s24, 875520
  buffer_load_dwordx4 v112, s[8:11], s27 offen  lds
  v_mfma_f32_32x32x16_bf16 v[48:63], v[92:95], v[120:123], v[48:63]
  s_waitcnt lgkmcnt(6)
  v_mfma_f32_32x32x16_bf16 v[0:15], v[64:67], v[96:99], v[0:15]
  ds_read_b128 v[100:103], v109 offset:0
  ds_read_b64_tr_b16 v[80:81], v104 offset:4096
  ds_read_b64_tr_b16 v[82:83], v104 offset:5120
  ds_read_b64_tr_b16 v[84:85], v105 offset:4096
  ds_read_b64_tr_b16 v[86:87], v105 offset:5120
  ds_read_b64_tr_b16 v[88:89], v106 offset:4096
  ds_read_b64_tr_b16 v[90:91], v106 offset:5120
  ds_read_b64_tr_b16 v[92:93], v107 offset:4096
  ds_read_b64_tr_b16 v[94:95], v107 offset:5120
  ds_read_b128 v[116:119], v110 offset:0
  ds_read_b128 v[120:123], v111 offset:0
  s_waitcnt lgkmcnt(15)
  v_mfma_f32_32x32x16_bf16 v[16:31], v[68:71], v[96:99], v[16:31]
  s_waitcnt lgkmcnt(13)
  v_mfma_f32_32x32x16_bf16 v[32:47], v[72:75], v[96:99], v[32:47]
  s_waitcnt lgkmcnt(11)
  v_mfma_f32_32x32x16_bf16 v[48:63], v[76:79], v[96:99], v[48:63]
  s_waitcnt lgkmcnt(8)
  v_mfma_f32_32x32x16_bf16 v[0:15], v[80:83], v[100:103], v[0:15]
  s_waitcnt vmcnt(8) lgkmcnt(0)
  s_barrier
  ds_read_b64_tr_b16 v[64:65], v104 offset:8192
  ds_read_b64_tr_b16 v[66:67], v104 offset:9216
  ds_read_b64_tr_b16 v[68:69], v105 offset:8192
  ds_read_b64_tr_b16 v[70:71], v105 offset:9216
  ds_read_b64_tr_b16 v[72:73], v106 offset:8192
  ds_read_b64_tr_b16 v[74:75], v106 offset:9216
  ds_read_b64_tr_b16 v[76:77], v107 offset:8192
  ds_read_b64_tr_b16 v[78:79], v107 offset:9216
  v_mfma_f32_32x32x16_bf16 v[16:31], v[84:87], v[100:103], v[16:31]
  s_add_u32 m0, s22, 0
  s_add_u32 s27, s24, 983040
  buffer_load_dwordx4 v112, s[8:11], s27 offen  lds
  s_add_u32 m0, s22, 1024
  s_add_u32 s27, s24, 998400
  buffer_load_dwordx4 v112, s[8:11], s27 offen  lds
  v_mfma_f32_32x32x16_bf16 v[32:47], v[88:91], v[100:103], v[32:47]
  s_add_u32 m0, s26, 16384
  s_add_u32 s28, s25, 512
  buffer_load_dwordx4 v113, s[12:15], s28 offen  lds
  s_add_u32 m0, s26, 17408
  s_add_u32 s28, s25, 10752
  buffer_load_dwordx4 v114, s[12:15], s28 offen  lds
  v_mfma_f32_32x32x16_bf16 v[48:63], v[92:95], v[100:103], v[48:63]
  s_add_u32 m0, s26, 18432
  s_add_u32 s28, s25, 20992
  buffer_load_dwordx4 v113, s[12:15], s28 offen  lds
  s_add_u32 m0, s26, 19456
  s_add_u32 s28, s25, 31232
  buffer_load_dwordx4 v114, s[12:15], s28 offen  lds
  s_waitcnt lgkmcnt(6)
  v_mfma_f32_32x32x16_bf16 v[0:15], v[64:67], v[116:119], v[0:15]
  ds_read_b64_tr_b16 v[80:81], v104 offset:12288
  ds_read_b64_tr_b16 v[82:83], v104 offset:13312
  ds_read_b64_tr_b16 v[84:85], v105 offset:12288
  ds_read_b64_tr_b16 v[86:87], v105 offset:13312
  ds_read_b64_tr_b16 v[88:89], v106 offset:12288
  ds_read_b64_tr_b16 v[90:91], v106 offset:13312
  ds_read_b64_tr_b16 v[92:93], v107 offset:12288
  ds_read_b64_tr_b16 v[94:95], v107 offset:13312
  s_waitcnt lgkmcnt(12)
  v_mfma_f32_32x32x16_bf16 v[16:31], v[68:71], v[116:119], v[16:31]
  s_waitcnt lgkmcnt(10)
  v_mfma_f32_32x32x16_bf16 v[32:47], v[72:75], v[116:119], v[32:47]
  s_waitcnt lgkmcnt(8)
  v_mfma_f32_32x32x16_bf16 v[48:63], v[76:79], v[116:119], v[48:63]
  s_waitcnt lgkmcnt(6)
  v_mfma_f32_32x32x16_bf16 v[0:15], v[80:83], v[120:123], v[0:15]
  s_waitcnt vmcnt(8) lgkmcnt(0)
  s_barrier
  ds_read_b128 v[96:99], v108 offset:32768
  ds_read_b64_tr_b16 v[64:65], v104 offset:32768
  ds_read_b64_tr_b16 v[66:67], v104 offset:33792
  ds_read_b64_tr_b16 v[68:69], v105 offset:32768
  ds_read_b64_tr_b16 v[70:71], v105 offset:33792
  ds_read_b64_tr_b16 v[72:73], v106 offset:32768
  ds_read_b64_tr_b16 v[74:75], v106 offset:33792
  ds_read_b64_tr_b16 v[76:77], v107 offset:32768
  ds_read_b64_tr_b16 v[78:79], v107 offset:33792
  v_mfma_f32_32x32x16_bf16 v[16:31], v[84:87], v[120:123], v[16:31]
  s_add_u32 m0, s22, 8192
  s_add_u32 s27, s24, 1105920
  buffer_load_dwordx4 v112, s[8:11], s27 offen  lds
  v_mfma_f32_32x32x16_bf16 v[32:47], v[88:91], v[120:123], v[32:47]
  s_add_u32 m0, s22, 9216
  s_add_u32 s27, s24, 1121280
  buffer_load_dwordx4 v112, s[8:11], s27 offen  lds
  v_mfma_f32_32x32x16_bf16 v[48:63], v[92:95], v[120:123], v[48:63]
  s_waitcnt lgkmcnt(6)
  v_mfma_f32_32x32x16_bf16 v[0:15], v[64:67], v[96:99], v[0:15]
  ds_read_b128 v[100:103], v109 offset:32768
  ds_read_b64_tr_b16 v[80:81], v104 offset:36864
  ds_read_b64_tr_b16 v[82:83], v104 offset:37888
  ds_read_b64_tr_b16 v[84:85], v105 offset:36864
  ds_read_b64_tr_b16 v[86:87], v105 offset:37888
  ds_read_b64_tr_b16 v[88:89], v106 offset:36864
  ds_read_b64_tr_b16 v[90:91], v106 offset:37888
  ds_read_b64_tr_b16 v[92:93], v107 offset:36864
  ds_read_b64_tr_b16 v[94:95], v107 offset:37888
  ds_read_b128 v[116:119], v110 offset:32768
  ds_read_b128 v[120:123], v111 offset:32768
  s_waitcnt lgkmcnt(15)
  v_mfma_f32_32x32x16_bf16 v[16:31], v[68:71], v[96:99], v[16:31]
  s_waitcnt lgkmcnt(13)
  v_mfma_f32_32x32x16_bf16 v[32:47], v[72:75], v[96:99], v[32:47]
  s_waitcnt lgkmcnt(11)
  v_mfma_f32_32x32x16_bf16 v[48:63], v[76:79], v[96:99], v[48:63]
  s_waitcnt lgkmcnt(8)
  v_mfma_f32_32x32x16_bf16 v[0:15], v[80:83], v[100:103], v[0:15]
  s_waitcnt vmcnt(8) lgkmcnt(0)
  s_barrier
  ds_read_b64_tr_b16 v[64:65], v104 offset:40960
  ds_read_b64_tr_b16 v[66:67], v104 offset:41984
  ds_read_b64_tr_b16 v[68:69], v105 offset:40960
  ds_read_b64_tr_b16 v[70:71], v105 offset:41984
  ds_read_b64_tr_b16 v[72:73], v106 offset:40960
  ds_read_b64_tr_b16 v[74:75], v106 offset:41984
  ds_read_b64_tr_b16 v[76:77], v107 offset:40960
  ds_read_b64_tr_b16 v[78:79], v107 offset:41984
  v_mfma_f32_32x32x16_bf16 v[16:31], v[84:87], v[100:103], v[16:31]
  s_add_u32 m0, s22, 32768
  s_add_u32 s27, s24, 1228800
  buffer_load_dwordx4 v112, s[8:11], s27 offen  lds
  s_add_u32 m0, s22, 33792
  s_add_u32 s27, s24, 1244160
  buffer_load_dwordx4 v112, s[8:11], s27 offen  lds
  v_mfma_f32_32x32x16_bf16 v[32:47], v[88:91], v[100:103], v[32:47]
  s_add_u32 m0, s26, 49152
  s_add_u32 s28, s25, 640
  buffer_load_dwordx4 v113, s[12:15], s28 offen  lds
  s_add_u32 m0, s26, 50176
  s_add_u32 s28, s25, 10880
  buffer_load_dwordx4 v114, s[12:15], s28 offen  lds
  v_mfma_f32_32x32x16_bf16 v[48:63], v[92:95], v[100:103], v[48:63]
  s_add_u32 m0, s26, 51200
  s_add_u32 s28, s25, 21120
  buffer_load_dwordx4 v113, s[12:15], s28 offen  lds
  s_add_u32 m0, s26, 52224
  s_add_u32 s28, s25, 31360
  buffer_load_dwordx4 v114, s[12:15], s28 offen  lds
  s_waitcnt lgkmcnt(6)
  v_mfma_f32_32x32x16_bf16 v[0:15], v[64:67], v[116:119], v[0:15]
  ds_read_b64_tr_b16 v[80:81], v104 offset:45056
  ds_read_b64_tr_b16 v[82:83], v104 offset:46080
  ds_read_b64_tr_b16 v[84:85], v105 offset:45056
  ds_read_b64_tr_b16 v[86:87], v105 offset:46080
  ds_read_b64_tr_b16 v[88:89], v106 offset:45056
  ds_read_b64_tr_b16 v[90:91], v106 offset:46080
  ds_read_b64_tr_b16 v[92:93], v107 offset:45056
  ds_read_b64_tr_b16 v[94:95], v107 offset:46080
  s_waitcnt lgkmcnt(12)
  v_mfma_f32_32x32x16_bf16 v[16:31], v[68:71], v[116:119], v[16:31]
  s_waitcnt lgkmcnt(10)
  v_mfma_f32_32x32x16_bf16 v[32:47], v[72:75], v[116:119], v[32:47]
  s_waitcnt lgkmcnt(8)
  v_mfma_f32_32x32x16_bf16 v[48:63], v[76:79], v[116:119], v[48:63]
  s_waitcnt lgkmcnt(6)
  v_mfma_f32_32x32x16_bf16 v[0:15], v[80:83], v[120:123], v[0:15]
  s_waitcnt vmcnt(8) lgkmcnt(0)
  s_barrier
  ds_read_b128 v[96:99], v108 offset:0
  ds_read_b64_tr_b16 v[64:65], v104 offset:0
  ds_read_b64_tr_b16 v[66:67], v104 offset:1024
  ds_read_b64_tr_b16 v[68:69], v105 offset:0
  ds_read_b64_tr_b16 v[70:71], v105 offset:1024
  ds_read_b64_tr_b16 v[72:73], v106 offset:0
  ds_read_b64_tr_b16 v[74:75], v106 offset:1024
  ds_read_b64_tr_b16 v[76:77], v107 offset:0
  ds_read_b64_tr_b16 v[78:79], v107 offset:1024
  v_mfma_f32_32x32x16_bf16 v[16:31], v[84:87], v[120:123], v[16:31]
  s_add_u32 m0, s22, 40960
  s_add_u32 s27, s24, 1351680
  buffer_load_dwordx4 v112, s[8:11], s27 offen  lds
  v_mfma_f32_32x32x16_bf16 v[32:47], v[88:91], v[120:123], v[32:47]
  s_add_u32 m0, s22, 41984
  s_add_u32 s27, s24, 1367040
  buffer_load_dwordx4 v112, s[8:11], s27 offen  lds
  v_mfma_f32_32x32x16_bf16 v[48:63], v[92:95], v[120:123], v[48:63]
  s_waitcnt lgkmcnt(6)
  v_mfma_f32_32x32x16_bf16 v[0:15], v[64:67], v[96:99], v[0:15]
  ds_read_b128 v[100:103], v109 offset:0
  ds_read_b64_tr_b16 v[80:81], v104 offset:4096
  ds_read_b64_tr_b16 v[82:83], v104 offset:5120
  ds_read_b64_tr_b16 v[84:85], v105 offset:4096
  ds_read_b64_tr_b16 v[86:87], v105 offset:5120
  ds_read_b64_tr_b16 v[88:89], v106 offset:4096
  ds_read_b64_tr_b16 v[90:91], v106 offset:5120
  ds_read_b64_tr_b16 v[92:93], v107 offset:4096
  ds_read_b64_tr_b16 v[94:95], v107 offset:5120
  ds_read_b128 v[116:119], v110 offset:0
  ds_read_b128 v[120:123], v111 offset:0
  s_waitcnt lgkmcnt(15)
  v_mfma_f32_32x32x16_bf16 v[16:31], v[68:71], v[96:99], v[16:31]
  s_waitcnt lgkmcnt(13)
  v_mfma_f32_32x32x16_bf16 v[32:47], v[72:75], v[96:99], v[32:47]
  s_waitcnt lgkmcnt(11)
  v_mfma_f32_32x32x16_bf16 v[48:63], v[76:79], v[96:99], v[48:63]
  s_waitcnt lgkmcnt(8)
  v_mfma_f32_32x32x16_bf16 v[0:15], v[80:83], v[100:103], v[0:15]
  s_waitcnt vmcnt(8) lgkmcnt(0)
  s_barrier
  ds_read_b64_tr_b16 v[64:65], v104 offset:8192
  ds_read_b64_tr_b16 v[66:67], v104 offset:9216
  ds_read_b64_tr_b16 v[68:69], v105 offset:8192
  ds_read_b64_tr_b16 v[70:71], v105 offset:9216
  ds_read_b64_tr_b16 v[72:73], v106 offset:8192
  ds_read_b64_tr_b16 v[74:75], v106 offset:9216
  ds_read_b64_tr_b16 v[76:77], v107 offset:8192
  ds_read_b64_tr_b16 v[78:79], v107 offset:9216
  v_mfma_f32_32x32x16_bf16 v[16:31], v[84:87], v[100:103], v[16:31]
  s_add_u32 m0, s22, 0
  s_add_u32 s27, s24, 1474560
  buffer_load_dwordx4 v112, s[8:11], s27 offen  lds
  s_add_u32 m0, s22, 1024
  s_add_u32 s27, s24, 1489920
  buffer_load_dwordx4 v112, s[8:11], s27 offen  lds
  v_mfma_f32_32x32x16_bf16 v[32:47], v[88:91], v[100:103], v[32:47]
  s_add_u32 m0, s26, 16384
  s_add_u32 s28, s25, 768
  buffer_load_dwordx4 v113, s[12:15], s28 offen  lds
  s_add_u32 m0, s26, 17408
  s_add_u32 s28, s25, 11008
  buffer_load_dwordx4 v114, s[12:15], s28 offen  lds
  v_mfma_f32_32x32x16_bf16 v[48:63], v[92:95], v[100:103], v[48:63]
  s_add_u32 m0, s26, 18432
  s_add_u32 s28, s25, 21248
  buffer_load_dwordx4 v113, s[12:15], s28 offen  lds
  s_add_u32 m0, s26, 19456
  s_add_u32 s28, s25, 31488
  buffer_load_dwordx4 v114, s[12:15], s28 offen  lds
  s_waitcnt lgkmcnt(6)
  v_mfma_f32_32x32x16_bf16 v[0:15], v[64:67], v[116:119], v[0:15]
  ds_read_b64_tr_b16 v[80:81], v104 offset:12288
  ds_read_b64_tr_b16 v[82:83], v104 offset:13312
  ds_read_b64_tr_b16 v[84:85], v105 offset:12288
  ds_read_b64_tr_b16 v[86:87], v105 offset:13312
  ds_read_b64_tr_b16 v[88:89], v106 offset:12288
  ds_read_b64_tr_b16 v[90:91], v106 offset:13312
  ds_read_b64_tr_b16 v[92:93], v107 offset:12288
  ds_read_b64_tr_b16 v[94:95], v107 offset:13312
  s_waitcnt lgkmcnt(12)
  v_mfma_f32_32x32x16_bf16 v[16:31], v[68:71], v[116:119], v[16:31]
  s_waitcnt lgkmcnt(10)
  v_mfma_f32_32x32x16_bf16 v[32:47], v[72:75], v[116:119], v[32:47]
  s_waitcnt lgkmcnt(8)
  v_mfma_f32_32x32x16_bf16 v[48:63], v[76:79], v[116:119], v[48:63]
  s_waitcnt lgkmcnt(6)
  v_mfma_f32_32x32x16_bf16 v[0:15], v[80:83], v[120:123], v[0:15]
  s_waitcnt vmcnt(8) lgkmcnt(0)
  s_barrier
  ds_read_b128 v[96:99], v108 offset:32768
  ds_read_b64_tr_b16 v[64:65], v104 offset:32768
  ds_read_b64_tr_b16 v[66:67], v104 offset:33792
  ds_read_b64_tr_b16 v[68:69], v105 offset:32768
  ds_read_b64_tr_b16 v[70:71], v105 offset:33792
  ds_read_b64_tr_b16 v[72:73], v106 offset:32768
  ds_read_b64_tr_b16 v[74:75], v106 offset:33792
  ds_read_b64_tr_b16 v[76:77], v107 offset:32768
  ds_read_b64_tr_b16 v[78:79], v107 offset:33792
  v_mfma_f32_32x32x16_bf16 v[16:31], v[84:87], v[120:123], v[16:31]
  s_add_u32 m0, s22, 8192
  s_add_u32 s27, s24, 1597440
  buffer_load_dwordx4 v112, s[8:11], s27 offen  lds
  v_mfma_f32_32x32x16_bf16 v[32:47], v[88:91], v[120:123], v[32:47]
  s_add_u32 m0, s22, 9216
  s_add_u32 s27, s24, 1612800
  buffer_load_dwordx4 v112, s[8:11], s27 offen  lds
  v_mfma_f32_32x32x16_bf16 v[48:63], v[92:95], v[120:123], v[48:63]
  s_waitcnt lgkmcnt(6)
  v_mfma_f32_32x32x16_bf16 v[0:15], v[64:67], v[96:99], v[0:15]
  ds_read_b128 v[100:103], v109 offset:32768
  ds_read_b64_tr_b16 v[80:81], v104 offset:36864
  ds_read_b64_tr_b16 v[82:83], v104 offset:37888
  ds_read_b64_tr_b16 v[84:85], v105 offset:36864
  ds_read_b64_tr_b16 v[86:87], v105 offset:37888
  ds_read_b64_tr_b16 v[88:89], v106 offset:36864
  ds_read_b64_tr_b16 v[90:91], v106 offset:37888
  ds_read_b64_tr_b16 v[92:93], v107 offset:36864
  ds_read_b64_tr_b16 v[94:95], v107 offset:37888
  ds_read_b128 v[116:119], v110 offset:32768
  ds_read_b128 v[120:123], v111 offset:32768
  s_waitcnt lgkmcnt(15)
  v_mfma_f32_32x32x16_bf16 v[16:31], v[68:71], v[96:99], v[16:31]
  s_waitcnt lgkmcnt(13)
  v_mfma_f32_32x32x16_bf16 v[32:47], v[72:75], v[96:99], v[32:47]
  s_waitcnt lgkmcnt(11)
  v_mfma_f32_32x32x16_bf16 v[48:63], v[76:79], v[96:99], v[48:63]
  s_waitcnt lgkmcnt(8)
  v_mfma_f32_32x32x16_bf16 v[0:15], v[80:83], v[100:103], v[0:15]
  s_waitcnt vmcnt(8) lgkmcnt(0)
  s_barrier
  ds_read_b64_tr_b16 v[64:65], v104 offset:40960
  ds_read_b64_tr_b16 v[66:67], v104 offset:41984
  ds_read_b64_tr_b16 v[68:69], v105 offset:40960
  ds_read_b64_tr_b16 v[70:71], v105 offset:41984
  ds_read_b64_tr_b16 v[72:73], v106 offset:40960
  ds_read_b64_tr_b16 v[74:75], v106 offset:41984
  ds_read_b64_tr_b16 v[76:77], v107 offset:40960
  ds_read_b64_tr_b16 v[78:79], v107 offset:41984
  v_mfma_f32_32x32x16_bf16 v[16:31], v[84:87], v[100:103], v[16:31]
  s_add_u32 m0, s22, 32768
  s_add_u32 s27, s24, 1720320
  buffer_load_dwordx4 v112, s[8:11], s27 offen  lds
  s_add_u32 m0, s22, 33792
  s_add_u32 s27, s24, 1735680
  buffer_load_dwordx4 v112, s[8:11], s27 offen  lds
  v_mfma_f32_32x32x16_bf16 v[32:47], v[88:91], v[100:103], v[32:47]
  s_add_u32 m0, s26, 49152
  s_add_u32 s28, s25, 896
  buffer_load_dwordx4 v113, s[12:15], s28 offen  lds
  s_add_u32 m0, s26, 50176
  s_add_u32 s28, s25, 11136
  buffer_load_dwordx4 v114, s[12:15], s28 offen  lds
  v_mfma_f32_32x32x16_bf16 v[48:63], v[92:95], v[100:103], v[48:63]
  s_add_u32 m0, s26, 51200
  s_add_u32 s28, s25, 21376
  buffer_load_dwordx4 v113, s[12:15], s28 offen  lds
  s_add_u32 m0, s26, 52224
  s_add_u32 s28, s25, 31616
  buffer_load_dwordx4 v114, s[12:15], s28 offen  lds
  s_waitcnt lgkmcnt(6)
  v_mfma_f32_32x32x16_bf16 v[0:15], v[64:67], v[116:119], v[0:15]
  ds_read_b64_tr_b16 v[80:81], v104 offset:45056
  ds_read_b64_tr_b16 v[82:83], v104 offset:46080
  ds_read_b64_tr_b16 v[84:85], v105 offset:45056
  ds_read_b64_tr_b16 v[86:87], v105 offset:46080
  ds_read_b64_tr_b16 v[88:89], v106 offset:45056
  ds_read_b64_tr_b16 v[90:91], v106 offset:46080
  ds_read_b64_tr_b16 v[92:93], v107 offset:45056
  ds_read_b64_tr_b16 v[94:95], v107 offset:46080
  s_waitcnt lgkmcnt(12)
  v_mfma_f32_32x32x16_bf16 v[16:31], v[68:71], v[116:119], v[16:31]
  s_waitcnt lgkmcnt(10)
  v_mfma_f32_32x32x16_bf16 v[32:47], v[72:75], v[116:119], v[32:47]
  s_waitcnt lgkmcnt(8)
  v_mfma_f32_32x32x16_bf16 v[48:63], v[76:79], v[116:119], v[48:63]
  s_waitcnt lgkmcnt(6)
  v_mfma_f32_32x32x16_bf16 v[0:15], v[80:83], v[120:123], v[0:15]
  s_waitcnt vmcnt(8) lgkmcnt(0)
  s_barrier
  ds_read_b128 v[96:99], v108 offset:0
  ds_read_b64_tr_b16 v[64:65], v104 offset:0
  ds_read_b64_tr_b16 v[66:67], v104 offset:1024
  ds_read_b64_tr_b16 v[68:69], v105 offset:0
  ds_read_b64_tr_b16 v[70:71], v105 offset:1024
  ds_read_b64_tr_b16 v[72:73], v106 offset:0
  ds_read_b64_tr_b16 v[74:75], v106 offset:1024
  ds_read_b64_tr_b16 v[76:77], v107 offset:0
  ds_read_b64_tr_b16 v[78:79], v107 offset:1024
  v_mfma_f32_32x32x16_bf16 v[16:31], v[84:87], v[120:123], v[16:31]
  s_add_u32 m0, s22, 40960
  s_add_u32 s27, s24, 1843200
  buffer_load_dwordx4 v112, s[8:11], s27 offen  lds
  v_mfma_f32_32x32x16_bf16 v[32:47], v[88:91], v[120:123], v[32:47]
  s_add_u32 m0, s22, 41984
  s_add_u32 s27, s24, 1858560
  buffer_load_dwordx4 v112, s[8:11], s27 offen  lds
  v_mfma_f32_32x32x16_bf16 v[48:63], v[92:95], v[120:123], v[48:63]
  s_waitcnt lgkmcnt(6)
  v_mfma_f32_32x32x16_bf16 v[0:15], v[64:67], v[96:99], v[0:15]
  ds_read_b128 v[100:103], v109 offset:0
  ds_read_b64_tr_b16 v[80:81], v104 offset:4096
  ds_read_b64_tr_b16 v[82:83], v104 offset:5120
  ds_read_b64_tr_b16 v[84:85], v105 offset:4096
  ds_read_b64_tr_b16 v[86:87], v105 offset:5120
  ds_read_b64_tr_b16 v[88:89], v106 offset:4096
  ds_read_b64_tr_b16 v[90:91], v106 offset:5120
  ds_read_b64_tr_b16 v[92:93], v107 offset:4096
  ds_read_b64_tr_b16 v[94:95], v107 offset:5120
  ds_read_b128 v[116:119], v110 offset:0
  ds_read_b128 v[120:123], v111 offset:0
  s_waitcnt lgkmcnt(15)
  v_mfma_f32_32x32x16_bf16 v[16:31], v[68:71], v[96:99], v[16:31]
  s_waitcnt lgkmcnt(13)
  v_mfma_f32_32x32x16_bf16 v[32:47], v[72:75], v[96:99], v[32:47]
  s_waitcnt lgkmcnt(11)
  v_mfma_f32_32x32x16_bf16 v[48:63], v[76:79], v[96:99], v[48:63]
  s_waitcnt lgkmcnt(8)
  v_mfma_f32_32x32x16_bf16 v[0:15], v[80:83], v[100:103], v[0:15]
  s_waitcnt vmcnt(8) lgkmcnt(0)
  s_barrier
  ds_read_b64_tr_b16 v[64:65], v104 offset:8192
  ds_read_b64_tr_b16 v[66:67], v104 offset:9216
  ds_read_b64_tr_b16 v[68:69], v105 offset:8192
  ds_read_b64_tr_b16 v[70:71], v105 offset:9216
  ds_read_b64_tr_b16 v[72:73], v106 offset:8192
  ds_read_b64_tr_b16 v[74:75], v106 offset:9216
  ds_read_b64_tr_b16 v[76:77], v107 offset:8192
  ds_read_b64_tr_b16 v[78:79], v107 offset:9216
  v_mfma_f32_32x32x16_bf16 v[16:31], v[84:87], v[100:103], v[16:31]
  s_add_u32 m0, s22, 0
  s_add_u32 s27, s24, 1966080
  buffer_load_dwordx4 v112, s[8:11], s27 offen  lds
  s_add_u32 m0, s22, 1024
  s_add_u32 s27, s24, 1981440
  buffer_load_dwordx4 v112, s[8:11], s27 offen  lds
  v_mfma_f32_32x32x16_bf16 v[32:47], v[88:91], v[100:103], v[32:47]
  s_add_u32 m0, s26, 16384
  s_add_u32 s28, s25, 1024
  buffer_load_dwordx4 v113, s[12:15], s28 offen  lds
  s_add_u32 m0, s26, 17408
  s_add_u32 s28, s25, 11264
  buffer_load_dwordx4 v114, s[12:15], s28 offen  lds
  v_mfma_f32_32x32x16_bf16 v[48:63], v[92:95], v[100:103], v[48:63]
  s_add_u32 m0, s26, 18432
  s_add_u32 s28, s25, 21504
  buffer_load_dwordx4 v113, s[12:15], s28 offen  lds
  s_add_u32 m0, s26, 19456
  s_add_u32 s28, s25, 31744
  buffer_load_dwordx4 v114, s[12:15], s28 offen  lds
  s_waitcnt lgkmcnt(6)
  v_mfma_f32_32x32x16_bf16 v[0:15], v[64:67], v[116:119], v[0:15]
  ds_read_b64_tr_b16 v[80:81], v104 offset:12288
  ds_read_b64_tr_b16 v[82:83], v104 offset:13312
  ds_read_b64_tr_b16 v[84:85], v105 offset:12288
  ds_read_b64_tr_b16 v[86:87], v105 offset:13312
  ds_read_b64_tr_b16 v[88:89], v106 offset:12288
  ds_read_b64_tr_b16 v[90:91], v106 offset:13312
  ds_read_b64_tr_b16 v[92:93], v107 offset:12288
  ds_read_b64_tr_b16 v[94:95], v107 offset:13312
  s_waitcnt lgkmcnt(12)
  v_mfma_f32_32x32x16_bf16 v[16:31], v[68:71], v[116:119], v[16:31]
  s_waitcnt lgkmcnt(10)
  v_mfma_f32_32x32x16_bf16 v[32:47], v[72:75], v[116:119], v[32:47]
  s_waitcnt lgkmcnt(8)
  v_mfma_f32_32x32x16_bf16 v[48:63], v[76:79], v[116:119], v[48:63]
  s_waitcnt lgkmcnt(6)
  v_mfma_f32_32x32x16_bf16 v[0:15], v[80:83], v[120:123], v[0:15]
  s_waitcnt vmcnt(8) lgkmcnt(0)
  s_barrier
  ds_read_b128 v[96:99], v108 offset:32768
  ds_read_b64_tr_b16 v[64:65], v104 offset:32768
  ds_read_b64_tr_b16 v[66:67], v104 offset:33792
  ds_read_b64_tr_b16 v[68:69], v105 offset:32768
  ds_read_b64_tr_b16 v[70:71], v105 offset:33792
  ds_read_b64_tr_b16 v[72:73], v106 offset:32768
  ds_read_b64_tr_b16 v[74:75], v106 offset:33792
  ds_read_b64_tr_b16 v[76:77], v107 offset:32768
  ds_read_b64_tr_b16 v[78:79], v107 offset:33792
  v_mfma_f32_32x32x16_bf16 v[16:31], v[84:87], v[120:123], v[16:31]
  s_add_u32 m0, s22, 8192
  s_add_u32 s27, s24, 2088960
  buffer_load_dwordx4 v112, s[8:11], s27 offen  lds
  v_mfma_f32_32x32x16_bf16 v[32:47], v[88:91], v[120:123], v[32:47]
  s_add_u32 m0, s22, 9216
  s_add_u32 s27, s24, 2104320
  buffer_load_dwordx4 v112, s[8:11], s27 offen  lds
  v_mfma_f32_32x32x16_bf16 v[48:63], v[92:95], v[120:123], v[48:63]
  s_waitcnt lgkmcnt(6)
  v_mfma_f32_32x32x16_bf16 v[0:15], v[64:67], v[96:99], v[0:15]
  ds_read_b128 v[100:103], v109 offset:32768
  ds_read_b64_tr_b16 v[80:81], v104 offset:36864
  ds_read_b64_tr_b16 v[82:83], v104 offset:37888
  ds_read_b64_tr_b16 v[84:85], v105 offset:36864
  ds_read_b64_tr_b16 v[86:87], v105 offset:37888
  ds_read_b64_tr_b16 v[88:89], v106 offset:36864
  ds_read_b64_tr_b16 v[90:91], v106 offset:37888
  ds_read_b64_tr_b16 v[92:93], v107 offset:36864
  ds_read_b64_tr_b16 v[94:95], v107 offset:37888
  ds_read_b128 v[116:119], v110 offset:32768
  ds_read_b128 v[120:123], v111 offset:32768
  s_waitcnt lgkmcnt(15)
  v_mfma_f32_32x32x16_bf16 v[16:31], v[68:71], v[96:99], v[16:31]
  s_waitcnt lgkmcnt(13)
  v_mfma_f32_32x32x16_bf16 v[32:47], v[72:75], v[96:99], v[32:47]
  s_waitcnt lgkmcnt(11)
  v_mfma_f32_32x32x16_bf16 v[48:63], v[76:79], v[96:99], v[48:63]
  s_waitcnt lgkmcnt(8)
  v_mfma_f32_32x32x16_bf16 v[0:15], v[80:83], v[100:103], v[0:15]
  s_waitcnt vmcnt(8) lgkmcnt(0)
  s_barrier
  ds_read_b64_tr_b16 v[64:65], v104 offset:40960
  ds_read_b64_tr_b16 v[66:67], v104 offset:41984
  ds_read_b64_tr_b16 v[68:69], v105 offset:40960
  ds_read_b64_tr_b16 v[70:71], v105 offset:41984
  ds_read_b64_tr_b16 v[72:73], v106 offset:40960
  ds_read_b64_tr_b16 v[74:75], v106 offset:41984
  ds_read_b64_tr_b16 v[76:77], v107 offset:40960
  ds_read_b64_tr_b16 v[78:79], v107 offset:41984
  v_mfma_f32_32x32x16_bf16 v[16:31], v[84:87], v[100:103], v[16:31]
  s_add_u32 m0, s22, 32768
  s_add_u32 s27, s24, 2211840
  buffer_load_dwordx4 v112, s[8:11], s27 offen  lds
  s_add_u32 m0, s22, 33792
  s_add_u32 s27, s24, 2227200
  buffer_load_dwordx4 v112, s[8:11], s27 offen  lds
  v_mfma_f32_32x32x16_bf16 v[32:47], v[88:91], v[100:103], v[32:47]
  s_add_u32 m0, s26, 49152
  s_add_u32 s28, s25, 1152
  buffer_load_dwordx4 v113, s[12:15], s28 offen  lds
  s_add_u32 m0, s26, 50176
  s_add_u32 s28, s25, 11392
  buffer_load_dwordx4 v114, s[12:15], s28 offen  lds
  v_mfma_f32_32x32x16_bf16 v[48:63], v[92:95], v[100:103], v[48:63]
  s_add_u32 m0, s26, 51200
  s_add_u32 s28, s25, 21632
  buffer_load_dwordx4 v113, s[12:15], s28 offen  lds
  s_add_u32 m0, s26, 52224
  s_add_u32 s28, s25, 31872
  buffer_load_dwordx4 v114, s[12:15], s28 offen  lds
  s_waitcnt lgkmcnt(6)
  v_mfma_f32_32x32x16_bf16 v[0:15], v[64:67], v[116:119], v[0:15]
  ds_read_b64_tr_b16 v[80:81], v104 offset:45056
  ds_read_b64_tr_b16 v[82:83], v104 offset:46080
  ds_read_b64_tr_b16 v[84:85], v105 offset:45056
  ds_read_b64_tr_b16 v[86:87], v105 offset:46080
  ds_read_b64_tr_b16 v[88:89], v106 offset:45056
  ds_read_b64_tr_b16 v[90:91], v106 offset:46080
  ds_read_b64_tr_b16 v[92:93], v107 offset:45056
  ds_read_b64_tr_b16 v[94:95], v107 offset:46080
  s_waitcnt lgkmcnt(12)
  v_mfma_f32_32x32x16_bf16 v[16:31], v[68:71], v[116:119], v[16:31]
  s_waitcnt lgkmcnt(10)
  v_mfma_f32_32x32x16_bf16 v[32:47], v[72:75], v[116:119], v[32:47]
  s_waitcnt lgkmcnt(8)
  v_mfma_f32_32x32x16_bf16 v[48:63], v[76:79], v[116:119], v[48:63]
  s_waitcnt lgkmcnt(6)
  v_mfma_f32_32x32x16_bf16 v[0:15], v[80:83], v[120:123], v[0:15]
  s_waitcnt vmcnt(8) lgkmcnt(0)
  s_barrier
  ds_read_b128 v[96:99], v108 offset:0
  ds_read_b64_tr_b16 v[64:65], v104 offset:0
  ds_read_b64_tr_b16 v[66:67], v104 offset:1024
  ds_read_b64_tr_b16 v[68:69], v105 offset:0
  ds_read_b64_tr_b16 v[70:71], v105 offset:1024
  ds_read_b64_tr_b16 v[72:73], v106 offset:0
  ds_read_b64_tr_b16 v[74:75], v106 offset:1024
  ds_read_b64_tr_b16 v[76:77], v107 offset:0
  ds_read_b64_tr_b16 v[78:79], v107 offset:1024
  v_mfma_f32_32x32x16_bf16 v[16:31], v[84:87], v[120:123], v[16:31]
  s_add_u32 m0, s22, 40960
  s_add_u32 s27, s24, 2334720
  buffer_load_dwordx4 v112, s[8:11], s27 offen  lds
  v_mfma_f32_32x32x16_bf16 v[32:47], v[88:91], v[120:123], v[32:47]
  s_add_u32 m0, s22, 41984
  s_add_u32 s27, s24, 2350080
  buffer_load_dwordx4 v112, s[8:11], s27 offen  lds
  v_mfma_f32_32x32x16_bf16 v[48:63], v[92:95], v[120:123], v[48:63]
  s_waitcnt lgkmcnt(6)
  v_mfma_f32_32x32x16_bf16 v[0:15], v[64:67], v[96:99], v[0:15]
  ds_read_b128 v[100:103], v109 offset:0
  ds_read_b64_tr_b16 v[80:81], v104 offset:4096
  ds_read_b64_tr_b16 v[82:83], v104 offset:5120
  ds_read_b64_tr_b16 v[84:85], v105 offset:4096
  ds_read_b64_tr_b16 v[86:87], v105 offset:5120
  ds_read_b64_tr_b16 v[88:89], v106 offset:4096
  ds_read_b64_tr_b16 v[90:91], v106 offset:5120
  ds_read_b64_tr_b16 v[92:93], v107 offset:4096
  ds_read_b64_tr_b16 v[94:95], v107 offset:5120
  ds_read_b128 v[116:119], v110 offset:0
  ds_read_b128 v[120:123], v111 offset:0
  s_waitcnt lgkmcnt(15)
  v_mfma_f32_32x32x16_bf16 v[16:31], v[68:71], v[96:99], v[16:31]
  s_waitcnt lgkmcnt(13)
  v_mfma_f32_32x32x16_bf16 v[32:47], v[72:75], v[96:99], v[32:47]
  s_waitcnt lgkmcnt(11)
  v_mfma_f32_32x32x16_bf16 v[48:63], v[76:79], v[96:99], v[48:63]
  s_waitcnt lgkmcnt(8)
  v_mfma_f32_32x32x16_bf16 v[0:15], v[80:83], v[100:103], v[0:15]
  s_waitcnt vmcnt(8) lgkmcnt(0)
  s_barrier
  ds_read_b64_tr_b16 v[64:65], v104 offset:8192
  ds_read_b64_tr_b16 v[66:67], v104 offset:9216
  ds_read_b64_tr_b16 v[68:69], v105 offset:8192
  ds_read_b64_tr_b16 v[70:71], v105 offset:9216
  ds_read_b64_tr_b16 v[72:73], v106 offset:8192
  ds_read_b64_tr_b16 v[74:75], v106 offset:9216
  ds_read_b64_tr_b16 v[76:77], v107 offset:8192
  ds_read_b64_tr_b16 v[78:79], v107 offset:9216
  v_mfma_f32_32x32x16_bf16 v[16:31], v[84:87], v[100:103], v[16:31]
  v_mfma_f32_32x32x16_bf16 v[32:47], v[88:91], v[100:103], v[32:47]
  v_mfma_f32_32x32x16_bf16 v[48:63], v[92:95], v[100:103], v[48:63]
  s_waitcnt lgkmcnt(6)
  v_mfma_f32_32x32x16_bf16 v[0:15], v[64:67], v[116:119], v[0:15]
  ds_read_b64_tr_b16 v[80:81], v104 offset:12288
  ds_read_b64_tr_b16 v[82:83], v104 offset:13312
  ds_read_b64_tr_b16 v[84:85], v105 offset:12288
  ds_read_b64_tr_b16 v[86:87], v105 offset:13312
  ds_read_b64_tr_b16 v[88:89], v106 offset:12288
  ds_read_b64_tr_b16 v[90:91], v106 offset:13312
  ds_read_b64_tr_b16 v[92:93], v107 offset:12288
  ds_read_b64_tr_b16 v[94:95], v107 offset:13312
  s_waitcnt lgkmcnt(12)
  v_mfma_f32_32x32x16_bf16 v[16:31], v[68:71], v[116:119], v[16:31]
  s_waitcnt lgkmcnt(10)
  v_mfma_f32_32x32x16_bf16 v[32:47], v[72:75], v[116:119], v[32:47]
  s_waitcnt lgkmcnt(8)
  v_mfma_f32_32x32x16_bf16 v[48:63], v[76:79], v[116:119], v[48:63]
  s_waitcnt lgkmcnt(6)
  v_mfma_f32_32x32x16_bf16 v[0:15], v[80:83], v[120:123], v[0:15]
  s_waitcnt vmcnt(2) lgkmcnt(0)
  s_barrier
  ds_read_b128 v[96:99], v108 offset:32768
  ds_read_b64_tr_b16 v[64:65], v104 offset:32768
  ds_read_b64_tr_b16 v[66:67], v104 offset:33792
  ds_read_b64_tr_b16 v[68:69], v105 offset:32768
  ds_read_b64_tr_b16 v[70:71], v105 offset:33792
  ds_read_b64_tr_b16 v[72:73], v106 offset:32768
  ds_read_b64_tr_b16 v[74:75], v106 offset:33792
  ds_read_b64_tr_b16 v[76:77], v107 offset:32768
  ds_read_b64_tr_b16 v[78:79], v107 offset:33792
  v_mfma_f32_32x32x16_bf16 v[16:31], v[84:87], v[120:123], v[16:31]
  v_mfma_f32_32x32x16_bf16 v[32:47], v[88:91], v[120:123], v[32:47]
  v_mfma_f32_32x32x16_bf16 v[48:63], v[92:95], v[120:123], v[48:63]
  s_waitcnt lgkmcnt(6)
  v_mfma_f32_32x32x16_bf16 v[0:15], v[64:67], v[96:99], v[0:15]
  ds_read_b128 v[100:103], v109 offset:32768
  ds_read_b64_tr_b16 v[80:81], v104 offset:36864
  ds_read_b64_tr_b16 v[82:83], v104 offset:37888
  ds_read_b64_tr_b16 v[84:85], v105 offset:36864
  ds_read_b64_tr_b16 v[86:87], v105 offset:37888
  ds_read_b64_tr_b16 v[88:89], v106 offset:36864
  ds_read_b64_tr_b16 v[90:91], v106 offset:37888
  ds_read_b64_tr_b16 v[92:93], v107 offset:36864
  ds_read_b64_tr_b16 v[94:95], v107 offset:37888
  ds_read_b128 v[116:119], v110 offset:32768
  ds_read_b128 v[120:123], v111 offset:32768
  s_waitcnt lgkmcnt(15)
  v_mfma_f32_32x32x16_bf16 v[16:31], v[68:71], v[96:99], v[16:31]
  s_waitcnt lgkmcnt(13)
  v_mfma_f32_32x32x16_bf16 v[32:47], v[72:75], v[96:99], v[32:47]
  s_waitcnt lgkmcnt(11)
  v_mfma_f32_32x32x16_bf16 v[48:63], v[76:79], v[96:99], v[48:63]
  s_waitcnt lgkmcnt(8)
  v_mfma_f32_32x32x16_bf16 v[0:15], v[80:83], v[100:103], v[0:15]
  s_waitcnt vmcnt(0) lgkmcnt(0)
  s_barrier
  ds_read_b64_tr_b16 v[64:65], v104 offset:40960
  ds_read_b64_tr_b16 v[66:67], v104 offset:41984
  ds_read_b64_tr_b16 v[68:69], v105 offset:40960
  ds_read_b64_tr_b16 v[70:71], v105 offset:41984
  ds_read_b64_tr_b16 v[72:73], v106 offset:40960
  ds_read_b64_tr_b16 v[74:75], v106 offset:41984
  ds_read_b64_tr_b16 v[76:77], v107 offset:40960
  ds_read_b64_tr_b16 v[78:79], v107 offset:41984
  v_mfma_f32_32x32x16_bf16 v[16:31], v[84:87], v[100:103], v[16:31]
  v_mfma_f32_32x32x16_bf16 v[32:47], v[88:91], v[100:103], v[32:47]
  v_mfma_f32_32x32x16_bf16 v[48:63], v[92:95], v[100:103], v[48:63]
  s_waitcnt lgkmcnt(6)
  v_mfma_f32_32x32x16_bf16 v[0:15], v[64:67], v[116:119], v[0:15]
  ds_read_b64_tr_b16 v[80:81], v104 offset:45056
  ds_read_b64_tr_b16 v[82:83], v104 offset:46080
  ds_read_b64_tr_b16 v[84:85], v105 offset:45056
  ds_read_b64_tr_b16 v[86:87], v105 offset:46080
  ds_read_b64_tr_b16 v[88:89], v106 offset:45056
  ds_read_b64_tr_b16 v[90:91], v106 offset:46080
  ds_read_b64_tr_b16 v[92:93], v107 offset:45056
  ds_read_b64_tr_b16 v[94:95], v107 offset:46080
  s_waitcnt lgkmcnt(12)
  v_mfma_f32_32x32x16_bf16 v[16:31], v[68:71], v[116:119], v[16:31]
  s_waitcnt lgkmcnt(10)
  v_mfma_f32_32x32x16_bf16 v[32:47], v[72:75], v[116:119], v[32:47]
  s_waitcnt lgkmcnt(8)
  v_mfma_f32_32x32x16_bf16 v[48:63], v[76:79], v[116:119], v[48:63]
  s_waitcnt lgkmcnt(6)
  v_mfma_f32_32x32x16_bf16 v[0:15], v[80:83], v[120:123], v[0:15]
  s_waitcnt lgkmcnt(4)
  v_mfma_f32_32x32x16_bf16 v[16:31], v[84:87], v[120:123], v[16:31]
  s_waitcnt lgkmcnt(2)
  v_mfma_f32_32x32x16_bf16 v[32:47], v[88:91], v[120:123], v[32:47]
  s_waitcnt lgkmcnt(0)
  v_mfma_f32_32x32x16_bf16 v[48:63], v[92:95], v[120:123], v[48:63]
  s_setprio 3
  v_lshrrev_b32 v104, 5, v115
  v_bfe_u32 v105, v115, 4, 1
  v_bfe_u32 v106, v115, 2, 2
  v_and_b32 v107, 3, v115
  v_and_b32 v116, 1, v107
  v_cmp_eq_u32 vcc, v116, v104
  v_lshrrev_b32 v116, 1, v107
  v_lshl_add_u32 v116, v105, 1, v116
  v_mul_u32_u24 v117, 40, v106
  v_lshl_add_u32 v118, v116, 3, v117
  v_add_u32 v118, 65536, v118
  v_mov_b32 v119, 67584
  v_cndmask_b32 v108, v119, v118, vcc
  v_cmp_eq_u32 s[34:35], 0, v116
  s_nop 1
  s_and_b64 vcc, vcc, s[34:35]
  v_add_u32 v118, 32, v118
  v_cndmask_b32 v109, v119, v118, vcc
  v_cvt_pk_bf16_f32 v64, v0, v1
  v_cvt_pk_bf16_f32 v65, v2, v3
  v_cvt_pk_bf16_f32 v66, v4, v5
  v_cvt_pk_bf16_f32 v67, v6, v7
  v_cvt_pk_bf16_f32 v68, v8, v9
  v_cvt_pk_bf16_f32 v69, v10, v11
  v_cvt_pk_bf16_f32 v70, v12, v13
  v_cvt_pk_bf16_f32 v71, v14, v15
  v_cvt_pk_bf16_f32 v72, v16, v17
  v_cvt_pk_bf16_f32 v73, v18, v19
  v_mov_b32 v74, 0
  v_mov_b32 v75, 0
  v_cvt_pk_bf16_f32 v76, v20, v21
  v_cvt_pk_bf16_f32 v77, v22, v23
  v_cvt_pk_bf16_f32 v78, v24, v25
  v_cvt_pk_bf16_f32 v79, v26, v27
  v_cvt_pk_bf16_f32 v80, v28, v29
  v_cvt_pk_bf16_f32 v81, v30, v31
  v_cvt_pk_bf16_f32 v82, v32, v33
  v_cvt_pk_bf16_f32 v83, v34, v35
  v_cvt_pk_bf16_f32 v84, v36, v37
  v_cvt_pk_bf16_f32 v85, v38, v39
  v_mov_b32 v86, 0
  v_mov_b32 v87, 0
  v_cvt_pk_bf16_f32 v88, v40, v41
  v_cvt_pk_bf16_f32 v89, v42, v43
  v_cvt_pk_bf16_f32 v90, v44, v45
  v_cvt_pk_bf16_f32 v91, v46, v47
  v_cvt_pk_bf16_f32 v92, v48, v49
  v_cvt_pk_bf16_f32 v93, v50, v51
  v_cvt_pk_bf16_f32 v94, v52, v53
  v_cvt_pk_bf16_f32 v95, v54, v55
  v_cvt_pk_bf16_f32 v96, v56, v57
  v_cvt_pk_bf16_f32 v97, v58, v59
  v_mov_b32 v98, 16256
  v_mov_b32 v99, 0
  v_and_b32 v110, 31, v115
  s_lshl_b32 s3, s29, 5
  v_add_u32 v110, s3, v110
  v_mul_u32_u24 v116, 48, v110
  v_mul_u32_u24 v117, 6144, v104
  s_movk_i32 s3, 20480
  v_add3_u32 v116, v116, v117, s3
  s_barrier
  ds_write_b128 v116, v[88:91] offset:0
  ds_write_b128 v116, v[92:95] offset:16
  ds_write_b128 v116, v[96:99] offset:32
  s_waitcnt lgkmcnt(0)
  ds_read_b64_tr_b16 v[88:89], v108 offset:0
  ds_read_b64_tr_b16 v[90:91], v108 offset:160
  s_waitcnt lgkmcnt(0)
  v_mfma_f32_32x32x16_bf16 v[0:15], v[88:91], v[64:67], 0
  ds_read_b64_tr_b16 v[92:93], v108 offset:320
  ds_read_b64_tr_b16 v[94:95], v108 offset:480
  s_waitcnt lgkmcnt(0)
  v_mfma_f32_32x32x16_bf16 v[0:15], v[92:95], v[68:71], v[0:15]
  ds_read_b64_tr_b16 v[96:97], v108 offset:640
  v_mov_b32 v98, 0
  v_mov_b32 v99, 0
  s_waitcnt lgkmcnt(0)
  s_nop 0
  v_mfma_f32_32x32x16_bf16 v[0:15], v[96:99], v[72:75], v[0:15]
  ds_read_b64_tr_b16 v[92:93], v109 offset:0
  ds_read_b64_tr_b16 v[94:95], v109 offset:160
  s_waitcnt lgkmcnt(0)
  v_mfma_f32_32x32x16_bf16 v[16:31], v[92:95], v[64:67], 0
  ds_read_b64_tr_b16 v[96:97], v109 offset:320
  ds_read_b64_tr_b16 v[98:99], v109 offset:480
  s_waitcnt lgkmcnt(0)
  v_mfma_f32_32x32x16_bf16 v[16:31], v[96:99], v[68:71], v[16:31]
  ds_read_b64_tr_b16 v[88:89], v109 offset:640
  v_mov_b32 v90, 0
  v_mov_b32 v91, 0
  s_waitcnt lgkmcnt(0)
  s_nop 0
  v_mfma_f32_32x32x16_bf16 v[16:31], v[88:91], v[72:75], v[16:31]
  ds_read_b64_tr_b16 v[96:97], v108 offset:800
  ds_read_b64_tr_b16 v[98:99], v108 offset:960
  s_waitcnt lgkmcnt(0)
  v_mfma_f32_32x32x16_bf16 v[32:47], v[96:99], v[76:79], 0
  ds_read_b64_tr_b16 v[88:89], v108 offset:1120
  ds_read_b64_tr_b16 v[90:91], v108 offset:1280
  s_waitcnt lgkmcnt(0)
  v_mfma_f32_32x32x16_bf16 v[32:47], v[88:91], v[80:83], v[32:47]
  ds_read_b64_tr_b16 v[92:93], v108 offset:1440
  v_mov_b32 v94, 0
  v_mov_b32 v95, 0
  s_waitcnt lgkmcnt(0)
  s_nop 0
  v_mfma_f32_32x32x16_bf16 v[32:47], v[92:95], v[84:87], v[32:47]
  ds_read_b64_tr_b16 v[88:89], v109 offset:800
  ds_read_b64_tr_b16 v[90:91], v109 offset:960
  s_waitcnt lgkmcnt(0)
  v_mfma_f32_32x32x16_bf16 v[48:63], v[88:91], v[76:79], 0
  ds_read_b64_tr_b16 v[92:93], v109 offset:1120
  ds_read_b64_tr_b16 v[94:95], v109 offset:1280
  s_waitcnt lgkmcnt(0)
  v_mfma_f32_32x32x16_bf16 v[48:63], v[92:95], v[80:83], v[48:63]
  ds_read_b64_tr_b16 v[96:97], v109 offset:1440
  v_mov_b32 v98, 0
  v_mov_b32 v99, 0
  s_waitcnt lgkmcnt(0)
  s_nop 0
  v_mfma_f32_32x32x16_bf16 v[48:63], v[96:99], v[84:87], v[48:63]
  s_mov_b32 s3, 1069066811
  v_max3_f32 v116, v0, v1, v2
  v_min3_f32 v117, v0, v1, v2
  v_max3_f32 v116, v116, v3, v4
  v_min3_f32 v117, v117, v3, v4
  v_max3_f32 v116, v116, v5, v6
  v_min3_f32 v117, v117, v5, v6
  v_max3_f32 v116, v116, v7, v8
  v_min3_f32 v117, v117, v7, v8
  v_max3_f32 v116, v116, v9, v10
  v_min3_f32 v117, v117, v9, v10
  v_max3_f32 v116, v116, v11, v12
  v_min3_f32 v117, v117, v11, v12
  v_max3_f32 v116, v116, v13, v14
  v_min3_f32 v117, v117, v13, v14
  v_max3_f32 v116, v116, v15, v16
  v_min3_f32 v117, v117, v15, v16
  v_max3_f32 v116, v116, v17, v18
  v_min3_f32 v117, v117, v17, v18
  v_max_f32 v116, v116, v19
  v_min_f32 v117, v117, v19
  v_mul_f32 v116, s3, v116
  v_mul_f32 v117, s3, v117
  v_fma_f32 v120, -v0, s3, v117
  v_fma_f32 v0, v0, s3, -v116
  v_fma_f32 v121, -v1, s3, v117
  v_fma_f32 v1, v1, s3, -v116
  v_fma_f32 v122, -v2, s3, v117
  v_fma_f32 v2, v2, s3, -v116
  v_fma_f32 v123, -v3, s3, v117
  v_fma_f32 v3, v3, s3, -v116
  v_fma_f32 v124, -v4, s3, v117
  v_fma_f32 v4, v4, s3, -v116
  v_fma_f32 v125, -v5, s3, v117
  v_fma_f32 v5, v5, s3, -v116
  v_fma_f32 v126, -v6, s3, v117
  v_fma_f32 v6, v6, s3, -v116
  v_fma_f32 v127, -v7, s3, v117
  v_fma_f32 v7, v7, s3, -v116
  v_fma_f32 v20, -v8, s3, v117
  v_fma_f32 v8, v8, s3, -v116
  v_fma_f32 v21, -v9, s3, v117
  v_fma_f32 v9, v9, s3, -v116
  v_fma_f32 v22, -v10, s3, v117
  v_fma_f32 v10, v10, s3, -v116
  v_fma_f32 v23, -v11, s3, v117
  v_fma_f32 v11, v11, s3, -v116
  v_fma_f32 v24, -v12, s3, v117
  v_fma_f32 v12, v12, s3, -v116
  v_fma_f32 v25, -v13, s3, v117
  v_fma_f32 v13, v13, s3, -v116
  v_fma_f32 v26, -v14, s3, v117
  v_fma_f32 v14, v14, s3, -v116
  v_fma_f32 v27, -v15, s3, v117
  v_fma_f32 v15, v15, s3, -v116
  v_fma_f32 v28, -v16, s3, v117
  v_fma_f32 v16, v16, s3, -v116
  v_fma_f32 v29, -v17, s3, v117
  v_fma_f32 v17, v17, s3, -v116
  v_fma_f32 v30, -v18, s3, v117
  v_fma_f32 v18, v18, s3, -v116
  v_fma_f32 v31, -v19, s3, v117
  v_fma_f32 v19, v19, s3, -v116
  v_exp_f32 v120, v120
  v_exp_f32 v0, v0
  v_exp_f32 v121, v121
  v_exp_f32 v1, v1
  v_exp_f32 v122, v122
  v_exp_f32 v2, v2
  v_exp_f32 v123, v123
  v_exp_f32 v3, v3
  v_exp_f32 v124, v124
  v_exp_f32 v4, v4
  v_exp_f32 v125, v125
  v_exp_f32 v5, v5
  v_exp_f32 v126, v126
  v_exp_f32 v6, v6
  v_exp_f32 v127, v127
  v_exp_f32 v7, v7
  v_exp_f32 v20, v20
  v_exp_f32 v8, v8
  v_exp_f32 v21, v21
  v_exp_f32 v9, v9
  v_exp_f32 v22, v22
  v_exp_f32 v10, v10
  v_exp_f32 v23, v23
  v_exp_f32 v11, v11
  v_exp_f32 v24, v24
  v_exp_f32 v12, v12
  v_exp_f32 v25, v25
  v_exp_f32 v13, v13
  v_exp_f32 v26, v26
  v_exp_f32 v14, v14
  v_exp_f32 v27, v27
  v_exp_f32 v15, v15
  v_exp_f32 v28, v28
  v_exp_f32 v16, v16
  v_exp_f32 v29, v29
  v_exp_f32 v17, v17
  v_exp_f32 v30, v30
  v_exp_f32 v18, v18
  v_exp_f32 v31, v31
  v_exp_f32 v19, v19
  v_add_f32 v118, v0, v1
  v_add_f32 v119, v120, v121
  v_add_f32 v118, v118, v2
  v_add_f32 v119, v119, v122
  v_add_f32 v118, v118, v3
  v_add_f32 v119, v119, v123
  v_add_f32 v118, v118, v4
  v_add_f32 v119, v119, v124
  v_add_f32 v118, v118, v5
  v_add_f32 v119, v119, v125
  v_add_f32 v118, v118, v6
  v_add_f32 v119, v119, v126
  v_add_f32 v118, v118, v7
  v_add_f32 v119, v119, v127
  v_add_f32 v118, v118, v8
  v_add_f32 v119, v119, v20
  v_add_f32 v118, v118, v9
  v_add_f32 v119, v119, v21
  v_add_f32 v118, v118, v10
  v_add_f32 v119, v119, v22
  v_add_f32 v118, v118, v11
  v_add_f32 v119, v119, v23
  v_add_f32 v118, v118, v12
  v_add_f32 v119, v119, v24
  v_add_f32 v118, v118, v13
  v_add_f32 v119, v119, v25
  v_add_f32 v118, v118, v14
  v_add_f32 v119, v119, v26
  v_add_f32 v118, v118, v15
  v_add_f32 v119, v119, v27
  v_add_f32 v118, v118, v16
  v_add_f32 v119, v119, v28
  v_add_f32 v118, v118, v17
  v_add_f32 v119, v119, v29
  v_add_f32 v118, v118, v18
  v_add_f32 v119, v119, v30
  v_add_f32 v118, v118, v19
  v_add_f32 v119, v119, v31
  v_rcp_f32 v118, v118
  v_rcp_f32 v119, v119
  v_mul_f32 v0, v118, v0
  v_mul_f32 v120, v119, v120
  v_mul_f32 v1, v118, v1
  v_mul_f32 v121, v119, v121
  v_mul_f32 v2, v118, v2
  v_mul_f32 v122, v119, v122
  v_mul_f32 v3, v118, v3
  v_mul_f32 v123, v119, v123
  v_mul_f32 v4, v118, v4
  v_mul_f32 v124, v119, v124
  v_mul_f32 v5, v118, v5
  v_mul_f32 v125, v119, v125
  v_mul_f32 v6, v118, v6
  v_mul_f32 v126, v119, v126
  v_mul_f32 v7, v118, v7
  v_mul_f32 v127, v119, v127
  v_mul_f32 v8, v118, v8
  v_mul_f32 v20, v119, v20
  v_mul_f32 v9, v118, v9
  v_mul_f32 v21, v119, v21
  v_mul_f32 v10, v118, v10
  v_mul_f32 v22, v119, v22
  v_mul_f32 v11, v118, v11
  v_mul_f32 v23, v119, v23
  v_mul_f32 v12, v118, v12
  v_mul_f32 v24, v119, v24
  v_mul_f32 v13, v118, v13
  v_mul_f32 v25, v119, v25
  v_mul_f32 v14, v118, v14
  v_mul_f32 v26, v119, v26
  v_mul_f32 v15, v118, v15
  v_mul_f32 v27, v119, v27
  v_mul_f32 v16, v118, v16
  v_mul_f32 v28, v119, v28
  v_mul_f32 v17, v118, v17
  v_mul_f32 v29, v119, v29
  v_mul_f32 v18, v118, v18
  v_mul_f32 v30, v119, v30
  v_mul_f32 v19, v118, v19
  v_mul_f32 v31, v119, v31
  v_cvt_pk_bf16_f32 v64, v0, v1
  v_cvt_pk_bf16_f32 v74, v120, v121
  v_cvt_pk_bf16_f32 v65, v2, v3
  v_cvt_pk_bf16_f32 v75, v122, v123
  v_cvt_pk_bf16_f32 v66, v4, v5
  v_cvt_pk_bf16_f32 v76, v124, v125
  v_cvt_pk_bf16_f32 v67, v6, v7
  v_cvt_pk_bf16_f32 v77, v126, v127
  v_cvt_pk_bf16_f32 v68, v8, v9
  v_cvt_pk_bf16_f32 v78, v20, v21
  v_cvt_pk_bf16_f32 v69, v10, v11
  v_cvt_pk_bf16_f32 v79, v22, v23
  v_cvt_pk_bf16_f32 v70, v12, v13
  v_cvt_pk_bf16_f32 v80, v24, v25
  v_cvt_pk_bf16_f32 v71, v14, v15
  v_cvt_pk_bf16_f32 v81, v26, v27
  v_cvt_pk_bf16_f32 v72, v16, v17
  v_cvt_pk_bf16_f32 v82, v28, v29
  v_cvt_pk_bf16_f32 v73, v18, v19
  v_cvt_pk_bf16_f32 v83, v30, v31
  v_max3_f32 v116, v32, v33, v34
  v_min3_f32 v117, v32, v33, v34
  v_max3_f32 v116, v116, v35, v36
  v_min3_f32 v117, v117, v35, v36
  v_max3_f32 v116, v116, v37, v38
  v_min3_f32 v117, v117, v37, v38
  v_max3_f32 v116, v116, v39, v40
  v_min3_f32 v117, v117, v39, v40
  v_max3_f32 v116, v116, v41, v42
  v_min3_f32 v117, v117, v41, v42
  v_max3_f32 v116, v116, v43, v44
  v_min3_f32 v117, v117, v43, v44
  v_max3_f32 v116, v116, v45, v46
  v_min3_f32 v117, v117, v45, v46
  v_max3_f32 v116, v116, v47, v48
  v_min3_f32 v117, v117, v47, v48
  v_max3_f32 v116, v116, v49, v50
  v_min3_f32 v117, v117, v49, v50
  v_max_f32 v116, v116, v51
  v_min_f32 v117, v117, v51
  v_mul_f32 v116, s3, v116
  v_mul_f32 v117, s3, v117
  v_fma_f32 v120, -v32, s3, v117
  v_fma_f32 v32, v32, s3, -v116
  v_fma_f32 v121, -v33, s3, v117
  v_fma_f32 v33, v33, s3, -v116
  v_fma_f32 v122, -v34, s3, v117
  v_fma_f32 v34, v34, s3, -v116
  v_fma_f32 v123, -v35, s3, v117
  v_fma_f32 v35, v35, s3, -v116
  v_fma_f32 v124, -v36, s3, v117
  v_fma_f32 v36, v36, s3, -v116
  v_fma_f32 v125, -v37, s3, v117
  v_fma_f32 v37, v37, s3, -v116
  v_fma_f32 v126, -v38, s3, v117
  v_fma_f32 v38, v38, s3, -v116
  v_fma_f32 v127, -v39, s3, v117
  v_fma_f32 v39, v39, s3, -v116
  v_fma_f32 v52, -v40, s3, v117
  v_fma_f32 v40, v40, s3, -v116
  v_fma_f32 v53, -v41, s3, v117
  v_fma_f32 v41, v41, s3, -v116
  v_fma_f32 v54, -v42, s3, v117
  v_fma_f32 v42, v42, s3, -v116
  v_fma_f32 v55, -v43, s3, v117
  v_fma_f32 v43, v43, s3, -v116
  v_fma_f32 v56, -v44, s3, v117
  v_fma_f32 v44, v44, s3, -v116
  v_fma_f32 v57, -v45, s3, v117
  v_fma_f32 v45, v45, s3, -v116
  v_fma_f32 v58, -v46, s3, v117
  v_fma_f32 v46, v46, s3, -v116
  v_fma_f32 v59, -v47, s3, v117
  v_fma_f32 v47, v47, s3, -v116
  v_fma_f32 v60, -v48, s3, v117
  v_fma_f32 v48, v48, s3, -v116
  v_fma_f32 v61, -v49, s3, v117
  v_fma_f32 v49, v49, s3, -v116
  v_fma_f32 v62, -v50, s3, v117
  v_fma_f32 v50, v50, s3, -v116
  v_fma_f32 v63, -v51, s3, v117
  v_fma_f32 v51, v51, s3, -v116
  v_exp_f32 v120, v120
  v_exp_f32 v32, v32
  v_exp_f32 v121, v121
  v_exp_f32 v33, v33
  v_exp_f32 v122, v122
  v_exp_f32 v34, v34
  v_exp_f32 v123, v123
  v_exp_f32 v35, v35
  v_exp_f32 v124, v124
  v_exp_f32 v36, v36
  v_exp_f32 v125, v125
  v_exp_f32 v37, v37
  v_exp_f32 v126, v126
  v_exp_f32 v38, v38
  v_exp_f32 v127, v127
  v_exp_f32 v39, v39
  v_exp_f32 v52, v52
  v_exp_f32 v40, v40
  v_exp_f32 v53, v53
  v_exp_f32 v41, v41
  v_exp_f32 v54, v54
  v_exp_f32 v42, v42
  v_exp_f32 v55, v55
  v_exp_f32 v43, v43
  v_exp_f32 v56, v56
  v_exp_f32 v44, v44
  v_exp_f32 v57, v57
  v_exp_f32 v45, v45
  v_exp_f32 v58, v58
  v_exp_f32 v46, v46
  v_exp_f32 v59, v59
  v_exp_f32 v47, v47
  v_exp_f32 v60, v60
  v_exp_f32 v48, v48
  v_exp_f32 v61, v61
  v_exp_f32 v49, v49
  v_exp_f32 v62, v62
  v_exp_f32 v50, v50
  v_exp_f32 v63, v63
  v_exp_f32 v51, v51
  v_add_f32 v118, v32, v33
  v_add_f32 v119, v120, v121
  v_add_f32 v118, v118, v34
  v_add_f32 v119, v119, v122
  v_add_f32 v118, v118, v35
  v_add_f32 v119, v119, v123
  v_add_f32 v118, v118, v36
  v_add_f32 v119, v119, v124
  v_add_f32 v118, v118, v37
  v_add_f32 v119, v119, v125
  v_add_f32 v118, v118, v38
  v_add_f32 v119, v119, v126
  v_add_f32 v118, v118, v39
  v_add_f32 v119, v119, v127
  v_add_f32 v118, v118, v40
  v_add_f32 v119, v119, v52
  v_add_f32 v118, v118, v41
  v_add_f32 v119, v119, v53
  v_add_f32 v118, v118, v42
  v_add_f32 v119, v119, v54
  v_add_f32 v118, v118, v43
  v_add_f32 v119, v119, v55
  v_add_f32 v118, v118, v44
  v_add_f32 v119, v119, v56
  v_add_f32 v118, v118, v45
  v_add_f32 v119, v119, v57
  v_add_f32 v118, v118, v46
  v_add_f32 v119, v119, v58
  v_add_f32 v118, v118, v47
  v_add_f32 v119, v119, v59
  v_add_f32 v118, v118, v48
  v_add_f32 v119, v119, v60
  v_add_f32 v118, v118, v49
  v_add_f32 v119, v119, v61
  v_add_f32 v118, v118, v50
  v_add_f32 v119, v119, v62
  v_add_f32 v118, v118, v51
  v_add_f32 v119, v119, v63
  v_rcp_f32 v118, v118
  v_rcp_f32 v119, v119
  v_mul_f32 v32, v118, v32
  v_mul_f32 v120, v119, v120
  v_mul_f32 v33, v118, v33
  v_mul_f32 v121, v119, v121
  v_mul_f32 v34, v118, v34
  v_mul_f32 v122, v119, v122
  v_mul_f32 v35, v118, v35
  v_mul_f32 v123, v119, v123
  v_mul_f32 v36, v118, v36
  v_mul_f32 v124, v119, v124
  v_mul_f32 v37, v118, v37
  v_mul_f32 v125, v119, v125
  v_mul_f32 v38, v118, v38
  v_mul_f32 v126, v119, v126
  v_mul_f32 v39, v118, v39
  v_mul_f32 v127, v119, v127
  v_mul_f32 v40, v118, v40
  v_mul_f32 v52, v119, v52
  v_mul_f32 v41, v118, v41
  v_mul_f32 v53, v119, v53
  v_mul_f32 v42, v118, v42
  v_mul_f32 v54, v119, v54
  v_mul_f32 v43, v118, v43
  v_mul_f32 v55, v119, v55
  v_mul_f32 v44, v118, v44
  v_mul_f32 v56, v119, v56
  v_mul_f32 v45, v118, v45
  v_mul_f32 v57, v119, v57
  v_mul_f32 v46, v118, v46
  v_mul_f32 v58, v119, v58
  v_mul_f32 v47, v118, v47
  v_mul_f32 v59, v119, v59
  v_mul_f32 v48, v118, v48
  v_mul_f32 v60, v119, v60
  v_mul_f32 v49, v118, v49
  v_mul_f32 v61, v119, v61
  v_mul_f32 v50, v118, v50
  v_mul_f32 v62, v119, v62
  v_mul_f32 v51, v118, v51
  v_mul_f32 v63, v119, v63
  v_cvt_pk_bf16_f32 v84, v32, v33
  v_cvt_pk_bf16_f32 v94, v120, v121
  v_cvt_pk_bf16_f32 v85, v34, v35
  v_cvt_pk_bf16_f32 v95, v122, v123
  v_cvt_pk_bf16_f32 v86, v36, v37
  v_cvt_pk_bf16_f32 v96, v124, v125
  v_cvt_pk_bf16_f32 v87, v38, v39
  v_cvt_pk_bf16_f32 v97, v126, v127
  v_cvt_pk_bf16_f32 v88, v40, v41
  v_cvt_pk_bf16_f32 v98, v52, v53
  v_cvt_pk_bf16_f32 v89, v42, v43
  v_cvt_pk_bf16_f32 v99, v54, v55
  v_cvt_pk_bf16_f32 v90, v44, v45
  v_cvt_pk_bf16_f32 v100, v56, v57
  v_cvt_pk_bf16_f32 v91, v46, v47
  v_cvt_pk_bf16_f32 v101, v58, v59
  v_cvt_pk_bf16_f32 v92, v48, v49
  v_cvt_pk_bf16_f32 v102, v60, v61
  v_cvt_pk_bf16_f32 v93, v50, v51
  v_cvt_pk_bf16_f32 v103, v62, v63
  v_permlane32_swap_b32 v64, v84
  v_permlane32_swap_b32 v65, v85
  v_permlane32_swap_b32 v66, v86
  v_permlane32_swap_b32 v67, v87
  v_permlane32_swap_b32 v68, v88
  v_permlane32_swap_b32 v69, v89
  v_permlane32_swap_b32 v70, v90
  v_permlane32_swap_b32 v71, v91
  v_permlane32_swap_b32 v72, v92
  v_permlane32_swap_b32 v73, v93
  v_permlane32_swap_b32 v74, v94
  v_permlane32_swap_b32 v75, v95
  v_permlane32_swap_b32 v76, v96
  v_permlane32_swap_b32 v77, v97
  v_permlane32_swap_b32 v78, v98
  v_permlane32_swap_b32 v79, v99
  v_permlane32_swap_b32 v80, v100
  v_permlane32_swap_b32 v81, v101
  v_permlane32_swap_b32 v82, v102
  v_permlane32_swap_b32 v83, v103
  v_mul_u32_u24 v116, 80, v110
  v_mul_u32_u24 v117, 10240, v104
  v_add_u32 v116, v116, v117
  ds_write_b128 v116, v[84:87] offset:0
  ds_write_b128 v116, v[88:91] offset:16
  ds_write_b128 v116, v[92:95] offset:32
  ds_write_b128 v116, v[96:99] offset:48
  ds_write_b128 v116, v[100:103] offset:64
  s_lshl_b32 s3, s29, 6
  v_add_u32 v116, s3, v115
  v_min_u32 v116, 199, v116
  v_lshlrev_b32 v116, 7, v116
  s_bfe_u32 s3, s2, 0x50003
  s_mul_i32 s3, s3, 25600
  buffer_load_dword v125, v116, s[56:59], s3 offen
  buffer_load_dword v126, v116, s[84:87], s3 offen
  s_lshr_b32 s34, s29, 1
  s_and_b32 s35, s29, 1
  v_lshl_add_u32 v116, v104, 3, v106
  v_lshl_add_u32 v117, v105, 2, v107
  s_lshl_b32 s3, s35, 3
  v_add_u32 v118, s3, v117
  v_min_u32 v118, 9, v118
  v_min_u32 v117, 5, v117
  v_mul_u32_u24 v108, 80, v116
  v_lshl_add_u32 v108, v118, 3, v108
  s_mul_i32 s3, s34, 10240
  v_add_u32 v108, s3, v108
  v_mul_u32_u24 v109, 48, v116
  v_lshl_add_u32 v109, v117, 3, v109
  s_mul_i32 s3, s34, 6144
  s_add_u32 s3, s3, 20480
  v_add_u32 v109, s3, v109
  s_waitcnt lgkmcnt(0)
  s_barrier
  ds_read_b64_tr_b16 v[16:17], v108 offset:0
  ds_read_b64_tr_b16 v[20:21], v109 offset:0
  ds_read_b64_tr_b16 v[18:19], v108 offset:320
  ds_read_b64_tr_b16 v[22:23], v109 offset:192
  ds_read_b64_tr_b16 v[24:25], v108 offset:1280
  ds_read_b64_tr_b16 v[28:29], v109 offset:768
  ds_read_b64_tr_b16 v[26:27], v108 offset:1600
  ds_read_b64_tr_b16 v[30:31], v109 offset:960
  ds_read_b64_tr_b16 v[32:33], v108 offset:2560
  ds_read_b64_tr_b16 v[36:37], v109 offset:1536
  ds_read_b64_tr_b16 v[34:35], v108 offset:2880
  ds_read_b64_tr_b16 v[38:39], v109 offset:1728
  s_waitcnt lgkmcnt(0)
  ds_read_b64_tr_b16 v[40:41], v108 offset:3840
  ds_read_b64_tr_b16 v[44:45], v109 offset:2304
  ds_read_b64_tr_b16 v[42:43], v108 offset:4160
  ds_read_b64_tr_b16 v[46:47], v109 offset:2496
  s_waitcnt lgkmcnt(0)
  v_mfma_f32_32x32x16_bf16 v[0:15], v[16:19], v[20:23], 0
  v_mfma_f32_32x32x16_bf16 v[0:15], v[24:27], v[28:31], v[0:15]
  v_mfma_f32_32x32x16_bf16 v[0:15], v[32:35], v[36:39], v[0:15]
  v_mfma_f32_32x32x16_bf16 v[0:15], v[40:43], v[44:47], v[0:15]
  ds_read_b64_tr_b16 v[16:17], v108 offset:5120
  ds_read_b64_tr_b16 v[20:21], v109 offset:3072
  ds_read_b64_tr_b16 v[18:19], v108 offset:5440
  ds_read_b64_tr_b16 v[22:23], v109 offset:3264
  ds_read_b64_tr_b16 v[24:25], v108 offset:6400
  ds_read_b64_tr_b16 v[28:29], v109 offset:3840
  ds_read_b64_tr_b16 v[26:27], v108 offset:6720
  ds_read_b64_tr_b16 v[30:31], v109 offset:4032
  ds_read_b64_tr_b16 v[32:33], v108 offset:7680
  ds_read_b64_tr_b16 v[36:37], v109 offset:4608
  ds_read_b64_tr_b16 v[34:35], v108 offset:8000
  ds_read_b64_tr_b16 v[38:39], v109 offset:4800
  s_waitcnt lgkmcnt(0)
  ds_read_b64_tr_b16 v[40:41], v108 offset:8960
  ds_read_b64_tr_b16 v[44:45], v109 offset:5376
  ds_read_b64_tr_b16 v[42:43], v108 offset:9280
  ds_read_b64_tr_b16 v[46:47], v109 offset:5568
  s_waitcnt lgkmcnt(0)
  v_mfma_f32_32x32x16_bf16 v[0:15], v[16:19], v[20:23], v[0:15]
  v_mfma_f32_32x32x16_bf16 v[0:15], v[24:27], v[28:31], v[0:15]
  v_mfma_f32_32x32x16_bf16 v[0:15], v[32:35], v[36:39], v[0:15]
  v_mfma_f32_32x32x16_bf16 v[0:15], v[40:43], v[44:47], v[0:15]
  v_and_b32 v116, 31, v115
  v_cmp_lt_u32 vcc, 20, v116
  v_mul_u32_u24 v116, 160, v116
  v_lshl_add_u32 v116, v104, 4, v116
  v_mov_b32 v117, 0x40000000
  v_cndmask_b32 v116, v116, v117, vcc
  s_lshl_b32 s3, s33, 1
  s_add_u32 s3, s3, s34
  s_lshl_b32 s3, s3, 4
  s_add_u32 s3, s3, s32
  s_mul_i32 s3, s3, 3360
  s_lshl_b32 s38, s35, 7
  s_add_u32 s3, s3, s38
  s_add_u32 s3, s3, 14680064
  buffer_store_dwordx4 v[0:3], v116, s[16:19], s3 offen sc1
  s_cmp_eq_u32 s35, 1
  s_cbranch_scc1 b_st
  buffer_store_dwordx4 v[4:7], v116, s[16:19], s3 offen offset:32 sc1
  buffer_store_dwordx4 v[8:11], v116, s[16:19], s3 offen offset:64 sc1
  buffer_store_dwordx4 v[12:15], v116, s[16:19], s3 offen offset:96 sc1
b_st:
  s_waitcnt vmcnt(0)
  s_barrier
  s_cmp_lg_u32 s29, 0
  s_cbranch_scc1 bk_s
  s_and_b32 s3, s2, 0x11b
  v_lshrrev_b32 v116, 3, v115
  v_and_b32 v117, 7, v115
  v_lshlrev_b32 v116, 2, v116
  v_lshl_or_b32 v116, v117, 5, v116
  s_lshl_b32 s52, s32, 2
  v_or_b32 v116, s3, v116
  v_lshlrev_b32 v116, 9, v116
  v_mov_b32 v117, 1
  s_add_u32 s52, s52, 16400384
  s_mov_b64 exec, 0xffff
  buffer_store_dword v117, v116, s[16:19], s52 offen offset:0 sc1
  s_mov_b64 exec, -1
bk_s:
  s_cmp_lg_u32 s29, 0
  s_cbranch_scc1 bk_go
  s_mov_b64 exec, 65535
  v_lshlrev_b32 v116, 2, v115
  s_mov_b32 s53, 0
bk_p:
  s_add_u32 s53, s53, 1
  s_cmp_ge_u32 s53, 0x100000
  s_cbranch_scc1 bk_e
  buffer_load_dword v117, v116, s[16:19], s83 offen offset:0 sc1
  s_waitcnt vmcnt(0)
  v_cmp_ne_u32 vcc, 1, v117
  s_cbranch_vccnz bk_p
bk_e:
  s_mov_b64 exec, -1
bk_go:
  s_barrier
  s_setprio 0
  s_lshl_b32 s3, s29, 6
  v_add_u32 v111, s3, v115
  s_mul_i32 s34, s33, 107520
  s_add_u32 s34, s34, 14680064
  v_cmp_le_u32 vcc, 210, v111
  s_nop 1
  v_cndmask_b32 v116, 0, 1, vcc
  v_mul_u32_u24 v117, 50400, v116
  v_lshl_add_u32 v117, v111, 4, v117
  v_cmp_le_u32 vcc, 420, v111
  v_mov_b32 v118, 0x40000000
  s_nop 0
  v_cndmask_b32 v117, v117, v118, vcc
  s_mov_b32 s35, s34
  buffer_load_dwordx4 v[0:3], v117, s[16:19], s35 offen sc1
  s_add_u32 s35, s35, 3360
  buffer_load_dwordx4 v[4:7], v117, s[16:19], s35 offen sc1
  s_add_u32 s35, s35, 3360
  buffer_load_dwordx4 v[8:11], v117, s[16:19], s35 offen sc1
  s_add_u32 s35, s35, 3360
  buffer_load_dwordx4 v[12:15], v117, s[16:19], s35 offen sc1
  s_add_u32 s35, s35, 3360
  buffer_load_dwordx4 v[16:19], v117, s[16:19], s35 offen sc1
  s_add_u32 s35, s35, 3360
  buffer_load_dwordx4 v[20:23], v117, s[16:19], s35 offen sc1
  s_add_u32 s35, s35, 3360
  buffer_load_dwordx4 v[24:27], v117, s[16:19], s35 offen sc1
  s_add_u32 s35, s35, 3360
  buffer_load_dwordx4 v[28:31], v117, s[16:19], s35 offen sc1
  s_add_u32 s35, s35, 3360
  buffer_load_dwordx4 v[32:35], v117, s[16:19], s35 offen sc1
  s_add_u32 s35, s35, 3360
  buffer_load_dwordx4 v[36:39], v117, s[16:19], s35 offen sc1
  s_add_u32 s35, s35, 3360
  buffer_load_dwordx4 v[40:43], v117, s[16:19], s35 offen sc1
  s_add_u32 s35, s35, 3360
  buffer_load_dwordx4 v[44:47], v117, s[16:19], s35 offen sc1
  s_add_u32 s35, s35, 3360
  buffer_load_dwordx4 v[48:51], v117, s[16:19], s35 offen sc1
  s_add_u32 s35, s35, 3360
  buffer_load_dwordx4 v[52:55], v117, s[16:19], s35 offen sc1
  s_add_u32 s35, s35, 3360
  buffer_load_dwordx4 v[56:59], v117, s[16:19], s35 offen sc1
  s_add_u32 s35, s35, 3360
  buffer_load_dwordx4 v[60:63], v117, s[16:19], s35 offen sc1
  s_add_u32 s35, s35, 3360
  v_lshlrev_b32 v119, 3, v111
  v_add_u32 v119, 32768, v119
  v_add_u32 v111, 256, v111
  s_waitcnt vmcnt(14)
  v_add_f32 v0, v0, v4
  v_add_f32 v1, v1, v5
  v_add_f32 v2, v2, v6
  v_add_f32 v3, v3, v7
  s_waitcnt vmcnt(13)
  v_add_f32 v0, v0, v8
  v_add_f32 v1, v1, v9
  v_add_f32 v2, v2, v10
  v_add_f32 v3, v3, v11
  s_waitcnt vmcnt(12)
  v_add_f32 v0, v0, v12
  v_add_f32 v1, v1, v13
  v_add_f32 v2, v2, v14
  v_add_f32 v3, v3, v15
  s_waitcnt vmcnt(11)
  v_add_f32 v0, v0, v16
  v_add_f32 v1, v1, v17
  v_add_f32 v2, v2, v18
  v_add_f32 v3, v3, v19
  s_waitcnt vmcnt(10)
  v_add_f32 v0, v0, v20
  v_add_f32 v1, v1, v21
  v_add_f32 v2, v2, v22
  v_add_f32 v3, v3, v23
  s_waitcnt vmcnt(9)
  v_add_f32 v0, v0, v24
  v_add_f32 v1, v1, v25
  v_add_f32 v2, v2, v26
  v_add_f32 v3, v3, v27
  s_waitcnt vmcnt(8)
  v_add_f32 v0, v0, v28
  v_add_f32 v1, v1, v29
  v_add_f32 v2, v2, v30
  v_add_f32 v3, v3, v31
  s_waitcnt vmcnt(7)
  v_add_f32 v0, v0, v32
  v_add_f32 v1, v1, v33
  v_add_f32 v2, v2, v34
  v_add_f32 v3, v3, v35
  s_waitcnt vmcnt(6)
  v_add_f32 v0, v0, v36
  v_add_f32 v1, v1, v37
  v_add_f32 v2, v2, v38
  v_add_f32 v3, v3, v39
  s_waitcnt vmcnt(5)
  v_add_f32 v0, v0, v40
  v_add_f32 v1, v1, v41
  v_add_f32 v2, v2, v42
  v_add_f32 v3, v3, v43
  s_waitcnt vmcnt(4)
  v_add_f32 v0, v0, v44
  v_add_f32 v1, v1, v45
  v_add_f32 v2, v2, v46
  v_add_f32 v3, v3, v47
  s_waitcnt vmcnt(3)
  v_add_f32 v0, v0, v48
  v_add_f32 v1, v1, v49
  v_add_f32 v2, v2, v50
  v_add_f32 v3, v3, v51
  s_waitcnt vmcnt(2)
  v_add_f32 v0, v0, v52
  v_add_f32 v1, v1, v53
  v_add_f32 v2, v2, v54
  v_add_f32 v3, v3, v55
  s_waitcnt vmcnt(1)
  v_add_f32 v0, v0, v56
  v_add_f32 v1, v1, v57
  v_add_f32 v2, v2, v58
  v_add_f32 v3, v3, v59
  s_waitcnt vmcnt(0)
  v_add_f32 v0, v0, v60
  v_add_f32 v1, v1, v61
  v_add_f32 v2, v2, v62
  v_add_f32 v3, v3, v63
  v_cvt_pk_bf16_f32 v0, v0, v1
  v_cvt_pk_bf16_f32 v1, v2, v3
  ds_write_b64 v119, v[0:1]
  v_cmp_le_u32 vcc, 210, v111
  s_nop 1
  v_cndmask_b32 v116, 0, 1, vcc
  v_mul_u32_u24 v117, 50400, v116
  v_lshl_add_u32 v117, v111, 4, v117
  v_cmp_le_u32 vcc, 420, v111
  v_mov_b32 v118, 0x40000000
  s_nop 0
  v_cndmask_b32 v117, v117, v118, vcc
  s_mov_b32 s35, s34
  buffer_load_dwordx4 v[0:3], v117, s[16:19], s35 offen sc1
  s_add_u32 s35, s35, 3360
  buffer_load_dwordx4 v[4:7], v117, s[16:19], s35 offen sc1
  s_add_u32 s35, s35, 3360
  buffer_load_dwordx4 v[8:11], v117, s[16:19], s35 offen sc1
  s_add_u32 s35, s35, 3360
  buffer_load_dwordx4 v[12:15], v117, s[16:19], s35 offen sc1
  s_add_u32 s35, s35, 3360
  buffer_load_dwordx4 v[16:19], v117, s[16:19], s35 offen sc1
  s_add_u32 s35, s35, 3360
  buffer_load_dwordx4 v[20:23], v117, s[16:19], s35 offen sc1
  s_add_u32 s35, s35, 3360
  buffer_load_dwordx4 v[24:27], v117, s[16:19], s35 offen sc1
  s_add_u32 s35, s35, 3360
  buffer_load_dwordx4 v[28:31], v117, s[16:19], s35 offen sc1
  s_add_u32 s35, s35, 3360
  buffer_load_dwordx4 v[32:35], v117, s[16:19], s35 offen sc1
  s_add_u32 s35, s35, 3360
  buffer_load_dwordx4 v[36:39], v117, s[16:19], s35 offen sc1
  s_add_u32 s35, s35, 3360
  buffer_load_dwordx4 v[40:43], v117, s[16:19], s35 offen sc1
  s_add_u32 s35, s35, 3360
  buffer_load_dwordx4 v[44:47], v117, s[16:19], s35 offen sc1
  s_add_u32 s35, s35, 3360
  buffer_load_dwordx4 v[48:51], v117, s[16:19], s35 offen sc1
  s_add_u32 s35, s35, 3360
  buffer_load_dwordx4 v[52:55], v117, s[16:19], s35 offen sc1
  s_add_u32 s35, s35, 3360
  buffer_load_dwordx4 v[56:59], v117, s[16:19], s35 offen sc1
  s_add_u32 s35, s35, 3360
  buffer_load_dwordx4 v[60:63], v117, s[16:19], s35 offen sc1
  s_add_u32 s35, s35, 3360
  v_lshlrev_b32 v119, 3, v111
  v_add_u32 v119, 32768, v119
  v_add_u32 v111, 256, v111
  s_waitcnt vmcnt(14)
  v_add_f32 v0, v0, v4
  v_add_f32 v1, v1, v5
  v_add_f32 v2, v2, v6
  v_add_f32 v3, v3, v7
  s_waitcnt vmcnt(13)
  v_add_f32 v0, v0, v8
  v_add_f32 v1, v1, v9
  v_add_f32 v2, v2, v10
  v_add_f32 v3, v3, v11
  s_waitcnt vmcnt(12)
  v_add_f32 v0, v0, v12
  v_add_f32 v1, v1, v13
  v_add_f32 v2, v2, v14
  v_add_f32 v3, v3, v15
  s_waitcnt vmcnt(11)
  v_add_f32 v0, v0, v16
  v_add_f32 v1, v1, v17
  v_add_f32 v2, v2, v18
  v_add_f32 v3, v3, v19
  s_waitcnt vmcnt(10)
  v_add_f32 v0, v0, v20
  v_add_f32 v1, v1, v21
  v_add_f32 v2, v2, v22
  v_add_f32 v3, v3, v23
  s_waitcnt vmcnt(9)
  v_add_f32 v0, v0, v24
  v_add_f32 v1, v1, v25
  v_add_f32 v2, v2, v26
  v_add_f32 v3, v3, v27
  s_waitcnt vmcnt(8)
  v_add_f32 v0, v0, v28
  v_add_f32 v1, v1, v29
  v_add_f32 v2, v2, v30
  v_add_f32 v3, v3, v31
  s_waitcnt vmcnt(7)
  v_add_f32 v0, v0, v32
  v_add_f32 v1, v1, v33
  v_add_f32 v2, v2, v34
  v_add_f32 v3, v3, v35
  s_waitcnt vmcnt(6)
  v_add_f32 v0, v0, v36
  v_add_f32 v1, v1, v37
  v_add_f32 v2, v2, v38
  v_add_f32 v3, v3, v39
  s_waitcnt vmcnt(5)
  v_add_f32 v0, v0, v40
  v_add_f32 v1, v1, v41
  v_add_f32 v2, v2, v42
  v_add_f32 v3, v3, v43
  s_waitcnt vmcnt(4)
  v_add_f32 v0, v0, v44
  v_add_f32 v1, v1, v45
  v_add_f32 v2, v2, v46
  v_add_f32 v3, v3, v47
  s_waitcnt vmcnt(3)
  v_add_f32 v0, v0, v48
  v_add_f32 v1, v1, v49
  v_add_f32 v2, v2, v50
  v_add_f32 v3, v3, v51
  s_waitcnt vmcnt(2)
  v_add_f32 v0, v0, v52
  v_add_f32 v1, v1, v53
  v_add_f32 v2, v2, v54
  v_add_f32 v3, v3, v55
  s_waitcnt vmcnt(1)
  v_add_f32 v0, v0, v56
  v_add_f32 v1, v1, v57
  v_add_f32 v2, v2, v58
  v_add_f32 v3, v3, v59
  s_waitcnt vmcnt(0)
  v_add_f32 v0, v0, v60
  v_add_f32 v1, v1, v61
  v_add_f32 v2, v2, v62
  v_add_f32 v3, v3, v63
  v_cvt_pk_bf16_f32 v0, v0, v1
  v_cvt_pk_bf16_f32 v1, v2, v3
  ds_write_b64 v119, v[0:1]
  v_bfe_u32 v116, v115, 2, 1
  v_cmp_eq_u32 vcc, v116, v104
  v_bfe_u32 v117, v115, 3, 2
  v_lshl_add_u32 v117, v117, 2, v107
  v_mul_u32_u24 v118, 80, v117
  v_mul_u32_u24 v116, 1680, v104
  s_mov_b32 s3, 32768
  v_add3_u32 v118, v118, v116, s3
  v_mov_b32 v119, 67584
  v_cndmask_b32 v108, v119, v118, vcc
  v_cmp_ge_u32 s[34:35], 4, v117
  s_nop 1
  s_and_b64 vcc, vcc, s[34:35]
  v_add_u32 v118, 1280, v118
  v_cndmask_b32 v109, v119, v118, vcc
  s_waitcnt lgkmcnt(0)
  s_barrier
  ds_read_b128 v[32:35], v108 offset:0
  ds_read_b128 v[36:39], v108 offset:16
  ds_read_b128 v[40:43], v108 offset:32
  ds_read_b128 v[44:47], v108 offset:48
  ds_read_b128 v[48:51], v108 offset:64
  s_waitcnt lgkmcnt(4)
  v_mfma_f32_32x32x16_bf16 v[0:15], v[32:35], v[64:67], 0
  s_waitcnt lgkmcnt(3)
  v_mfma_f32_32x32x16_bf16 v[0:15], v[36:39], v[68:71], v[0:15]
  s_waitcnt lgkmcnt(2)
  v_mfma_f32_32x32x16_bf16 v[0:15], v[40:43], v[72:75], v[0:15]
  s_waitcnt lgkmcnt(1)
  v_mfma_f32_32x32x16_bf16 v[0:15], v[44:47], v[76:79], v[0:15]
  s_waitcnt lgkmcnt(0)
  v_mfma_f32_32x32x16_bf16 v[0:15], v[48:51], v[80:83], v[0:15]
  ds_read_b128 v[32:35], v109 offset:0
  ds_read_b128 v[36:39], v109 offset:16
  ds_read_b128 v[40:43], v109 offset:32
  ds_read_b128 v[44:47], v109 offset:48
  ds_read_b128 v[48:51], v109 offset:64
  s_waitcnt lgkmcnt(4)
  v_mfma_f32_32x32x16_bf16 v[16:31], v[32:35], v[64:67], 0
  s_waitcnt lgkmcnt(3)
  v_mfma_f32_32x32x16_bf16 v[16:31], v[36:39], v[68:71], v[16:31]
  s_waitcnt lgkmcnt(2)
  v_mfma_f32_32x32x16_bf16 v[16:31], v[40:43], v[72:75], v[16:31]
  s_waitcnt lgkmcnt(1)
  v_mfma_f32_32x32x16_bf16 v[16:31], v[44:47], v[76:79], v[16:31]
  s_waitcnt lgkmcnt(0)
  v_mfma_f32_32x32x16_bf16 v[16:31], v[48:51], v[80:83], v[16:31]
  v_and_b32 v116, 31, v115
  v_lshlrev_b32 v116, 4, v116
  v_lshl_add_u32 v117, v104, 3, v116
  v_mul_u32_u24 v118, 1536, v104
  v_add_u32 v116, v116, v118
  v_cmp_eq_u32 vcc, 1, v104
  s_lshl_b32 s3, s32, 2
  s_add_u32 s3, s3, s29
  s_mul_i32 s3, s3, 40960
  s_mul_i32 s34, s33, 2560
  s_add_u32 s3, s3, s34
  s_add_u32 s3, s3, 12058624
  v_add_f32 v20, 897988541, v20
  v_rcp_f32 v20, v20
  s_nop 0
  v_mul_f32 v0, v20, v0
  v_mul_f32 v1, v20, v1
  v_cvt_pk_bf16_f32 v32, v0, v1
  v_mul_f32 v2, v20, v2
  v_mul_f32 v3, v20, v3
  v_cvt_pk_bf16_f32 v33, v2, v3
  v_mul_f32 v4, v20, v4
  v_mul_f32 v5, v20, v5
  v_cvt_pk_bf16_f32 v34, v4, v5
  v_mul_f32 v6, v20, v6
  v_mul_f32 v7, v20, v7
  v_cvt_pk_bf16_f32 v35, v6, v7
  v_mul_f32 v8, v20, v8
  v_mul_f32 v9, v20, v9
  v_cvt_pk_bf16_f32 v36, v8, v9
  v_mul_f32 v10, v20, v10
  v_mul_f32 v11, v20, v11
  v_cvt_pk_bf16_f32 v37, v10, v11
  v_mul_f32 v12, v20, v12
  v_mul_f32 v13, v20, v13
  v_cvt_pk_bf16_f32 v38, v12, v13
  v_mul_f32 v14, v20, v14
  v_mul_f32 v15, v20, v15
  v_cvt_pk_bf16_f32 v39, v14, v15
  v_mul_f32 v16, v20, v16
  v_mul_f32 v17, v20, v17
  v_cvt_pk_bf16_f32 v40, v16, v17
  v_mul_f32 v18, v20, v18
  v_mul_f32 v19, v20, v19
  v_cvt_pk_bf16_f32 v41, v18, v19
  v_cndmask_b32 v44, v32, v34, vcc
  v_cndmask_b32 v45, v33, v35, vcc
  v_cndmask_b32 v46, v34, v36, vcc
  v_cndmask_b32 v47, v35, v37, vcc
  v_cndmask_b32 v48, v36, v38, vcc
  v_cndmask_b32 v49, v37, v39, vcc
  v_cndmask_b32 v50, v38, v40, vcc
  v_cndmask_b32 v51, v39, v41, vcc
  v_cndmask_b32 v52, v40, v32, vcc
  v_cndmask_b32 v53, v41, v33, vcc
  buffer_store_dwordx4 v[44:47], v116, s[16:19], s3 offen sc1
  buffer_store_dwordx4 v[48:51], v116, s[16:19], s3 offen offset:512 sc1
  buffer_store_dwordx2 v[52:53], v117, s[16:19], s3 offen offset:1024 sc1
  s_waitcnt vmcnt(0)
  s_barrier
  s_cmp_lg_u32 s29, 0
  s_cbranch_scc1 bo_s
  s_lshr_b32 s3, s32, 1
  s_and_b32 s52, s32, 1
  s_lshl_b32 s52, s52, 3
  s_or_b32 s3, s3, s52
  s_or_b32 s3, s3, 256
  v_lshlrev_b32 v116, 4, v115
  s_lshl_b32 s52, s33, 2
  v_or_b32 v116, s3, v116
  v_lshlrev_b32 v116, 9, v116
  v_mov_b32 v117, 1
  s_add_u32 s52, s52, 16400384
  s_mov_b64 exec, 0xffff
  buffer_store_dword v117, v116, s[16:19], s52 offen offset:128 sc1
  s_mov_b64 exec, -1
bo_s:
  s_setprio 0
  s_mov_b32 s39, 0
  s_mul_i32 s34, s55, 80
  s_lshl_b32 s35, s29, 10
  s_lshl_b32 s3, s29, 6
  v_add_u32 v0, s3, v115
  s_mov_b32 s36, 52429
  v_mul_u32_u24 v1, s36, v0
  v_lshrrev_b32 v1, 18, v1
  v_mul_u32_u24 v1, 1200, v1
  v_lshl_add_u32 v2, v0, 4, v1
  s_add_u32 m0, s35, 0
  v_add_u32 v0, 256, v0
  buffer_load_dwordx4 v2, s[56:59], s34 offen lds
  v_mul_u32_u24 v1, s36, v0
  v_lshrrev_b32 v1, 18, v1
  v_mul_u32_u24 v1, 1200, v1
  v_lshl_add_u32 v3, v0, 4, v1
  s_add_u32 m0, s35, 4096
  v_add_u32 v0, 256, v0
  buffer_load_dwordx4 v3, s[56:59], s34 offen lds
  v_mul_u32_u24 v1, s36, v0
  v_lshrrev_b32 v1, 18, v1
  v_mul_u32_u24 v1, 1200, v1
  v_lshl_add_u32 v4, v0, 4, v1
  s_add_u32 m0, s35, 8192
  v_add_u32 v0, 256, v0
  buffer_load_dwordx4 v4, s[56:59], s34 offen lds
  v_mul_u32_u24 v1, s36, v0
  v_lshrrev_b32 v1, 18, v1
  v_mul_u32_u24 v1, 1200, v1
  v_lshl_add_u32 v5, v0, 4, v1
  s_add_u32 m0, s35, 12288
  v_add_u32 v0, 256, v0
  buffer_load_dwordx4 v5, s[56:59], s34 offen lds
  v_mul_u32_u24 v1, s36, v0
  v_lshrrev_b32 v1, 18, v1
  v_mul_u32_u24 v1, 1200, v1
  v_lshl_add_u32 v6, v0, 4, v1
  s_add_u32 m0, s35, 16384
  v_add_u32 v0, 256, v0
  buffer_load_dwordx4 v6, s[56:59], s34 offen lds
  v_mul_u32_u24 v1, s36, v0
  v_lshrrev_b32 v1, 18, v1
  v_mul_u32_u24 v1, 1200, v1
  v_lshl_add_u32 v7, v0, 4, v1
  s_add_u32 m0, s35, 20480
  v_add_u32 v0, 256, v0
  buffer_load_dwordx4 v7, s[56:59], s34 offen lds
  v_mul_u32_u24 v1, s36, v0
  v_lshrrev_b32 v1, 18, v1
  v_mul_u32_u24 v1, 1200, v1
  v_lshl_add_u32 v8, v0, 4, v1
  s_add_u32 m0, s35, 24576
  v_add_u32 v0, 256, v0
  buffer_load_dwordx4 v8, s[56:59], s34 offen lds
  v_mul_u32_u24 v1, s36, v0
  v_lshrrev_b32 v1, 18, v1
  v_mul_u32_u24 v1, 1200, v1
  v_lshl_add_u32 v9, v0, 4, v1
  s_add_u32 m0, s35, 28672
  v_add_u32 v0, 256, v0
  buffer_load_dwordx4 v9, s[56:59], s34 offen lds
  v_mul_u32_u24 v1, s36, v0
  v_lshrrev_b32 v1, 18, v1
  v_mul_u32_u24 v1, 1200, v1
  v_lshl_add_u32 v10, v0, 4, v1
  s_add_u32 m0, s35, 32768
  v_add_u32 v0, 256, v0
  buffer_load_dwordx4 v10, s[56:59], s34 offen lds
  v_mul_u32_u24 v1, s36, v0
  v_lshrrev_b32 v1, 18, v1
  v_mul_u32_u24 v1, 1200, v1
  v_lshl_add_u32 v11, v0, 4, v1
  s_add_u32 m0, s35, 36864
  v_add_u32 v0, 256, v0
  buffer_load_dwordx4 v11, s[56:59], s34 offen lds
  v_mul_u32_u24 v1, s36, v0
  v_lshrrev_b32 v1, 18, v1
  v_mul_u32_u24 v1, 1200, v1
  v_lshl_add_u32 v12, v0, 4, v1
  s_add_u32 m0, s35, 40960
  v_add_u32 v0, 256, v0
  buffer_load_dwordx4 v12, s[56:59], s34 offen lds
  v_mul_u32_u24 v1, s36, v0
  v_lshrrev_b32 v1, 18, v1
  v_mul_u32_u24 v1, 1200, v1
  v_lshl_add_u32 v13, v0, 4, v1
  s_add_u32 m0, s35, 45056
  v_add_u32 v0, 256, v0
  buffer_load_dwordx4 v13, s[56:59], s34 offen lds
  s_cmp_ge_u32 s29, 2
  s_cbranch_scc1 f_nodB
  v_mul_u32_u24 v1, s36, v0
  v_lshrrev_b32 v1, 18, v1
  v_mul_u32_u24 v1, 1200, v1
  v_lshl_add_u32 v14, v0, 4, v1
  s_add_u32 m0, s35, 49152
  v_add_u32 v0, 256, v0
  buffer_load_dwordx4 v14, s[56:59], s34 offen lds
f_nodB:
  v_mov_b32 v127, v115
  v_bfe_u32 v0, v127, 2, 2
  v_lshrrev_b32 v1, 5, v127
  v_lshl_add_u32 v0, v1, 3, v0
  v_mul_u32_u24 v0, 80, v0
  s_mul_i32 s3, s39, 25600
  v_add_u32 v0, s3, v0
  v_and_b32 v1, 1, v127
  v_mul_u32_u24 v1, 40, v1
  v_add_u32 v0, v0, v1
  v_add_u32 v125, 32, v0
  v_bfe_u32 v1, v127, 1, 1
  v_bfe_u32 v16, v127, 4, 1
  v_lshl_add_u32 v1, v16, 1, v1
  v_lshl_add_u32 v124, v1, 3, v0
  v_lshlrev_b32 v126, 4, v127
  s_lshl_b32 s3, s54, 2
  s_and_b32 s36, s29, 3
  s_add_u32 s43, s3, s36
  s_mul_i32 s34, s43, 40960
  s_mul_i32 s3, s39, 20480
  s_add_u32 s34, s34, s3
  s_add_u32 s34, s34, 12058624
  s_waitcnt vmcnt(0)
  s_cmp_lg_u32 s29, 0
  s_cbranch_scc1 oB_go
  s_mov_b64 exec, 65535
  v_lshlrev_b32 v0, 2, v115
  s_mov_b32 s53, 0
oB_p:
  s_add_u32 s53, s53, 1
  s_cmp_ge_u32 s53, 0x100000
  s_cbranch_scc1 oB_e
  buffer_load_dword v1, v0, s[16:19], s83 offen offset:128 sc1
  s_waitcnt vmcnt(0)
  v_cmp_ne_u32 vcc, 1, v1
  s_cbranch_vccnz oB_p
oB_e:
  s_mov_b64 exec, -1
oB_go:
  s_barrier
  buffer_load_dwordx4 v[32:35], v126, s[16:19], s34 offen offset:0 sc1
  buffer_load_dwordx4 v[36:39], v126, s[16:19], s34 offen offset:1024 sc1
  buffer_load_dwordx4 v[40:43], v126, s[16:19], s34 offen offset:2048 sc1
  buffer_load_dwordx4 v[44:47], v126, s[16:19], s34 offen offset:3072 sc1
  s_add_u32 s34, s34, 4096
  buffer_load_dwordx4 v[48:51], v126, s[16:19], s34 offen offset:0 sc1
  buffer_load_dwordx4 v[52:55], v126, s[16:19], s34 offen offset:1024 sc1
  buffer_load_dwordx4 v[56:59], v126, s[16:19], s34 offen offset:2048 sc1
  buffer_load_dwordx4 v[60:63], v126, s[16:19], s34 offen offset:3072 sc1
  s_add_u32 s34, s34, 4096
  buffer_load_dwordx4 v[64:67], v126, s[16:19], s34 offen offset:0 sc1
  buffer_load_dwordx4 v[68:71], v126, s[16:19], s34 offen offset:1024 sc1
  buffer_load_dwordx4 v[72:75], v126, s[16:19], s34 offen offset:2048 sc1
  buffer_load_dwordx4 v[76:79], v126, s[16:19], s34 offen offset:3072 sc1
  s_add_u32 s34, s34, 4096
  buffer_load_dwordx4 v[80:83], v126, s[16:19], s34 offen offset:0 sc1
  buffer_load_dwordx4 v[84:87], v126, s[16:19], s34 offen offset:1024 sc1
  buffer_load_dwordx4 v[88:91], v126, s[16:19], s34 offen offset:2048 sc1
  buffer_load_dwordx4 v[92:95], v126, s[16:19], s34 offen offset:3072 sc1
  s_add_u32 s34, s34, 4096
  buffer_load_dwordx4 v[96:99], v126, s[16:19], s34 offen offset:0 sc1
  buffer_load_dwordx4 v[100:103], v126, s[16:19], s34 offen offset:1024 sc1
  buffer_load_dwordx4 v[104:107], v126, s[16:19], s34 offen offset:2048 sc1
  buffer_load_dwordx4 v[108:111], v126, s[16:19], s34 offen offset:3072 sc1
  s_add_u32 s34, s34, 4096
  ds_read_b64_tr_b16 v[112:113], v124 offset:0
  ds_read_b64_tr_b16 v[114:115], v124 offset:320
  ds_read_b64_tr_b16 v[116:117], v125 offset:0
  ds_read_b64_tr_b16 v[118:119], v125 offset:320
  ds_read_b64_tr_b16 v[120:121], v124 offset:1280
  ds_read_b64_tr_b16 v[122:123], v124 offset:1600
  s_waitcnt vmcnt(19) lgkmcnt(4)
  v_mfma_f32_32x32x16_bf16 v[0:15], v[112:115], v[32:35], 0
  ds_read_b64_tr_b16 v[112:113], v125 offset:1280
  ds_read_b64_tr_b16 v[114:115], v125 offset:1600
  s_waitcnt vmcnt(19) lgkmcnt(4)
  v_mfma_f32_32x32x16_bf16 v[16:31], v[116:119], v[32:35], 0
  ds_read_b64_tr_b16 v[116:117], v124 offset:2560
  ds_read_b64_tr_b16 v[118:119], v124 offset:2880
  s_waitcnt vmcnt(18) lgkmcnt(4)
  v_mfma_f32_32x32x16_bf16 v[0:15], v[120:123], v[36:39], v[0:15]
  buffer_load_dwordx4 v[32:35], v126, s[16:19], s34 offen offset:0 sc1
  ds_read_b64_tr_b16 v[120:121], v125 offset:2560
  ds_read_b64_tr_b16 v[122:123], v125 offset:2880
  s_waitcnt vmcnt(18) lgkmcnt(4)
  v_mfma_f32_32x32x16_bf16 v[16:31], v[112:115], v[36:39], v[16:31]
  ds_read_b64_tr_b16 v[112:113], v124 offset:3840
  ds_read_b64_tr_b16 v[114:115], v124 offset:4160
  s_waitcnt vmcnt(18) lgkmcnt(4)
  v_mfma_f32_32x32x16_bf16 v[0:15], v[116:119], v[40:43], v[0:15]
  buffer_load_dwordx4 v[36:39], v126, s[16:19], s34 offen offset:1024 sc1
  ds_read_b64_tr_b16 v[116:117], v125 offset:3840
  ds_read_b64_tr_b16 v[118:119], v125 offset:4160
  s_waitcnt vmcnt(18) lgkmcnt(4)
  v_mfma_f32_32x32x16_bf16 v[16:31], v[120:123], v[40:43], v[16:31]
  ds_read_b64_tr_b16 v[120:121], v124 offset:5120
  ds_read_b64_tr_b16 v[122:123], v124 offset:5440
  s_waitcnt vmcnt(18) lgkmcnt(4)
  v_mfma_f32_32x32x16_bf16 v[0:15], v[112:115], v[44:47], v[0:15]
  buffer_load_dwordx4 v[40:43], v126, s[16:19], s34 offen offset:2048 sc1
  ds_read_b64_tr_b16 v[112:113], v125 offset:5120
  ds_read_b64_tr_b16 v[114:115], v125 offset:5440
  s_waitcnt vmcnt(18) lgkmcnt(4)
  v_mfma_f32_32x32x16_bf16 v[16:31], v[116:119], v[44:47], v[16:31]
  ds_read_b64_tr_b16 v[116:117], v124 offset:6400
  ds_read_b64_tr_b16 v[118:119], v124 offset:6720
  s_waitcnt vmcnt(18) lgkmcnt(4)
  v_mfma_f32_32x32x16_bf16 v[0:15], v[120:123], v[48:51], v[0:15]
  buffer_load_dwordx4 v[44:47], v126, s[16:19], s34 offen offset:3072 sc1
  s_add_u32 s34, s34, 4096
  ds_read_b64_tr_b16 v[120:121], v125 offset:6400
  ds_read_b64_tr_b16 v[122:123], v125 offset:6720
  s_waitcnt vmcnt(18) lgkmcnt(4)
  v_mfma_f32_32x32x16_bf16 v[16:31], v[112:115], v[48:51], v[16:31]
  ds_read_b64_tr_b16 v[112:113], v124 offset:7680
  ds_read_b64_tr_b16 v[114:115], v124 offset:8000
  s_waitcnt vmcnt(18) lgkmcnt(4)
  v_mfma_f32_32x32x16_bf16 v[0:15], v[116:119], v[52:55], v[0:15]
  buffer_load_dwordx4 v[48:51], v126, s[16:19], s34 offen offset:0 sc1
  ds_read_b64_tr_b16 v[116:117], v125 offset:7680
  ds_read_b64_tr_b16 v[118:119], v125 offset:8000
  s_waitcnt vmcnt(18) lgkmcnt(4)
  v_mfma_f32_32x32x16_bf16 v[16:31], v[120:123], v[52:55], v[16:31]
  ds_read_b64_tr_b16 v[120:121], v124 offset:8960
  ds_read_b64_tr_b16 v[122:123], v124 offset:9280
  s_waitcnt vmcnt(18) lgkmcnt(4)
  v_mfma_f32_32x32x16_bf16 v[0:15], v[112:115], v[56:59], v[0:15]
  buffer_load_dwordx4 v[52:55], v126, s[16:19], s34 offen offset:1024 sc1
  ds_read_b64_tr_b16 v[112:113], v125 offset:8960
  ds_read_b64_tr_b16 v[114:115], v125 offset:9280
  s_waitcnt vmcnt(18) lgkmcnt(4)
  v_mfma_f32_32x32x16_bf16 v[16:31], v[116:119], v[56:59], v[16:31]
  ds_read_b64_tr_b16 v[116:117], v124 offset:10240
  ds_read_b64_tr_b16 v[118:119], v124 offset:10560
  s_waitcnt vmcnt(18) lgkmcnt(4)
  v_mfma_f32_32x32x16_bf16 v[0:15], v[120:123], v[60:63], v[0:15]
  buffer_load_dwordx4 v[56:59], v126, s[16:19], s34 offen offset:2048 sc1
  ds_read_b64_tr_b16 v[120:121], v125 offset:10240
  ds_read_b64_tr_b16 v[122:123], v125 offset:10560
  s_waitcnt vmcnt(18) lgkmcnt(4)
  v_mfma_f32_32x32x16_bf16 v[16:31], v[112:115], v[60:63], v[16:31]
  ds_read_b64_tr_b16 v[112:113], v124 offset:11520
  ds_read_b64_tr_b16 v[114:115], v124 offset:11840
  s_waitcnt vmcnt(18) lgkmcnt(4)
  v_mfma_f32_32x32x16_bf16 v[0:15], v[116:119], v[64:67], v[0:15]
  buffer_load_dwordx4 v[60:63], v126, s[16:19], s34 offen offset:3072 sc1
  s_add_u32 s34, s34, 4096
  ds_read_b64_tr_b16 v[116:117], v125 offset:11520
  ds_read_b64_tr_b16 v[118:119], v125 offset:11840
  s_waitcnt vmcnt(18) lgkmcnt(4)
  v_mfma_f32_32x32x16_bf16 v[16:31], v[120:123], v[64:67], v[16:31]
  ds_read_b64_tr_b16 v[120:121], v124 offset:12800
  ds_read_b64_tr_b16 v[122:123], v124 offset:13120
  s_waitcnt vmcnt(18) lgkmcnt(4)
  v_mfma_f32_32x32x16_bf16 v[0:15], v[112:115], v[68:71], v[0:15]
  buffer_load_dwordx4 v[64:67], v126, s[16:19], s34 offen offset:0 sc1
  ds_read_b64_tr_b16 v[112:113], v125 offset:12800
  ds_read_b64_tr_b16 v[114:115], v125 offset:13120
  s_waitcnt vmcnt(18) lgkmcnt(4)
  v_mfma_f32_32x32x16_bf16 v[16:31], v[116:119], v[68:71], v[16:31]
  ds_read_b64_tr_b16 v[116:117], v124 offset:14080
  ds_read_b64_tr_b16 v[118:119], v124 offset:14400
  s_waitcnt vmcnt(18) lgkmcnt(4)
  v_mfma_f32_32x32x16_bf16 v[0:15], v[120:123], v[72:75], v[0:15]
  buffer_load_dwordx4 v[68:71], v126, s[16:19], s34 offen offset:1024 sc1
  ds_read_b64_tr_b16 v[120:121], v125 offset:14080
  ds_read_b64_tr_b16 v[122:123], v125 offset:14400
  s_waitcnt vmcnt(18) lgkmcnt(4)
  v_mfma_f32_32x32x16_bf16 v[16:31], v[112:115], v[72:75], v[16:31]
  ds_read_b64_tr_b16 v[112:113], v124 offset:15360
  ds_read_b64_tr_b16 v[114:115], v124 offset:15680
  s_waitcnt vmcnt(18) lgkmcnt(4)
  v_mfma_f32_32x32x16_bf16 v[0:15], v[116:119], v[76:79], v[0:15]
  buffer_load_dwordx4 v[72:75], v126, s[16:19], s34 offen offset:2048 sc1
  ds_read_b64_tr_b16 v[116:117], v125 offset:15360
  ds_read_b64_tr_b16 v[118:119], v125 offset:15680
  s_waitcnt vmcnt(18) lgkmcnt(4)
  v_mfma_f32_32x32x16_bf16 v[16:31], v[120:123], v[76:79], v[16:31]
  ds_read_b64_tr_b16 v[120:121], v124 offset:16640
  ds_read_b64_tr_b16 v[122:123], v124 offset:16960
  s_waitcnt vmcnt(18) lgkmcnt(4)
  v_mfma_f32_32x32x16_bf16 v[0:15], v[112:115], v[80:83], v[0:15]
  buffer_load_dwordx4 v[76:79], v126, s[16:19], s34 offen offset:3072 sc1
  s_add_u32 s34, s34, 4096
  ds_read_b64_tr_b16 v[112:113], v125 offset:16640
  ds_read_b64_tr_b16 v[114:115], v125 offset:16960
  s_waitcnt vmcnt(18) lgkmcnt(4)
  v_mfma_f32_32x32x16_bf16 v[16:31], v[116:119], v[80:83], v[16:31]
  ds_read_b64_tr_b16 v[116:117], v124 offset:17920
  ds_read_b64_tr_b16 v[118:119], v124 offset:18240
  s_waitcnt vmcnt(18) lgkmcnt(4)
  v_mfma_f32_32x32x16_bf16 v[0:15], v[120:123], v[84:87], v[0:15]
  buffer_load_dwordx4 v[80:83], v126, s[16:19], s34 offen offset:0 sc1
  ds_read_b64_tr_b16 v[120:121], v125 offset:17920
  ds_read_b64_tr_b16 v[122:123], v125 offset:18240
  s_waitcnt vmcnt(18) lgkmcnt(4)
  v_mfma_f32_32x32x16_bf16 v[16:31], v[112:115], v[84:87], v[16:31]
  ds_read_b64_tr_b16 v[112:113], v124 offset:19200
  ds_read_b64_tr_b16 v[114:115], v124 offset:19520
  s_waitcnt vmcnt(18) lgkmcnt(4)
  v_mfma_f32_32x32x16_bf16 v[0:15], v[116:119], v[88:91], v[0:15]
  buffer_load_dwordx4 v[84:87], v126, s[16:19], s34 offen offset:1024 sc1
  ds_read_b64_tr_b16 v[116:117], v125 offset:19200
  ds_read_b64_tr_b16 v[118:119], v125 offset:19520
  s_waitcnt vmcnt(18) lgkmcnt(4)
  v_mfma_f32_32x32x16_bf16 v[16:31], v[120:123], v[88:91], v[16:31]
  ds_read_b64_tr_b16 v[120:121], v124 offset:20480
  ds_read_b64_tr_b16 v[122:123], v124 offset:20800
  s_waitcnt vmcnt(18) lgkmcnt(4)
  v_mfma_f32_32x32x16_bf16 v[0:15], v[112:115], v[92:95], v[0:15]
  buffer_load_dwordx4 v[88:91], v126, s[16:19], s34 offen offset:2048 sc1
  ds_read_b64_tr_b16 v[112:113], v125 offset:20480
  ds_read_b64_tr_b16 v[114:115], v125 offset:20800
  s_waitcnt vmcnt(18) lgkmcnt(4)
  v_mfma_f32_32x32x16_bf16 v[16:31], v[116:119], v[92:95], v[16:31]
  ds_read_b64_tr_b16 v[116:117], v124 offset:21760
  ds_read_b64_tr_b16 v[118:119], v124 offset:22080
  s_waitcnt vmcnt(18) lgkmcnt(4)
  v_mfma_f32_32x32x16_bf16 v[0:15], v[120:123], v[96:99], v[0:15]
  buffer_load_dwordx4 v[92:95], v126, s[16:19], s34 offen offset:3072 sc1
  s_add_u32 s34, s34, 4096
  ds_read_b64_tr_b16 v[120:121], v125 offset:21760
  ds_read_b64_tr_b16 v[122:123], v125 offset:22080
  s_waitcnt vmcnt(18) lgkmcnt(4)
  v_mfma_f32_32x32x16_bf16 v[16:31], v[112:115], v[96:99], v[16:31]
  ds_read_b64_tr_b16 v[112:113], v124 offset:23040
  ds_read_b64_tr_b16 v[114:115], v124 offset:23360
  s_waitcnt vmcnt(18) lgkmcnt(4)
  v_mfma_f32_32x32x16_bf16 v[0:15], v[116:119], v[100:103], v[0:15]
  buffer_load_dwordx4 v[96:99], v126, s[16:19], s34 offen offset:0 sc1
  ds_read_b64_tr_b16 v[116:117], v125 offset:23040
  ds_read_b64_tr_b16 v[118:119], v125 offset:23360
  s_waitcnt vmcnt(18) lgkmcnt(4)
  v_mfma_f32_32x32x16_bf16 v[16:31], v[120:123], v[100:103], v[16:31]
  ds_read_b64_tr_b16 v[120:121], v124 offset:24320
  ds_read_b64_tr_b16 v[122:123], v124 offset:24640
  s_waitcnt vmcnt(18) lgkmcnt(4)
  v_mfma_f32_32x32x16_bf16 v[0:15], v[112:115], v[104:107], v[0:15]
  buffer_load_dwordx4 v[100:103], v126, s[16:19], s34 offen offset:1024 sc1
  ds_read_b64_tr_b16 v[112:113], v125 offset:24320
  ds_read_b64_tr_b16 v[114:115], v125 offset:24640
  s_waitcnt vmcnt(18) lgkmcnt(4)
  v_mfma_f32_32x32x16_bf16 v[16:31], v[116:119], v[104:107], v[16:31]
  ds_read_b64_tr_b16 v[116:117], v124 offset:25600
  ds_read_b64_tr_b16 v[118:119], v124 offset:25920
  s_waitcnt vmcnt(18) lgkmcnt(4)
  v_mfma_f32_32x32x16_bf16 v[0:15], v[120:123], v[108:111], v[0:15]
  buffer_load_dwordx4 v[104:107], v126, s[16:19], s34 offen offset:2048 sc1
  ds_read_b64_tr_b16 v[120:121], v125 offset:25600
  ds_read_b64_tr_b16 v[122:123], v125 offset:25920
  s_waitcnt vmcnt(18) lgkmcnt(4)
  v_mfma_f32_32x32x16_bf16 v[16:31], v[112:115], v[108:111], v[16:31]
  ds_read_b64_tr_b16 v[112:113], v124 offset:26880
  ds_read_b64_tr_b16 v[114:115], v124 offset:27200
  s_waitcnt vmcnt(18) lgkmcnt(4)
  v_mfma_f32_32x32x16_bf16 v[0:15], v[116:119], v[32:35], v[0:15]
  buffer_load_dwordx4 v[108:111], v126, s[16:19], s34 offen offset:3072 sc1
  s_add_u32 s34, s34, 4096
  ds_read_b64_tr_b16 v[116:117], v125 offset:26880
  ds_read_b64_tr_b16 v[118:119], v125 offset:27200
  s_waitcnt vmcnt(18) lgkmcnt(4)
  v_mfma_f32_32x32x16_bf16 v[16:31], v[120:123], v[32:35], v[16:31]
  ds_read_b64_tr_b16 v[120:121], v124 offset:28160
  ds_read_b64_tr_b16 v[122:123], v124 offset:28480
  s_waitcnt vmcnt(18) lgkmcnt(4)
  v_mfma_f32_32x32x16_bf16 v[0:15], v[112:115], v[36:39], v[0:15]
  ds_read_b64_tr_b16 v[112:113], v125 offset:28160
  ds_read_b64_tr_b16 v[114:115], v125 offset:28480
  s_waitcnt vmcnt(18) lgkmcnt(4)
  v_mfma_f32_32x32x16_bf16 v[16:31], v[116:119], v[36:39], v[16:31]
  ds_read_b64_tr_b16 v[116:117], v124 offset:29440
  ds_read_b64_tr_b16 v[118:119], v124 offset:29760
  s_waitcnt vmcnt(17) lgkmcnt(4)
  v_mfma_f32_32x32x16_bf16 v[0:15], v[120:123], v[40:43], v[0:15]
  ds_read_b64_tr_b16 v[120:121], v125 offset:29440
  ds_read_b64_tr_b16 v[122:123], v125 offset:29760
  s_waitcnt vmcnt(17) lgkmcnt(4)
  v_mfma_f32_32x32x16_bf16 v[16:31], v[112:115], v[40:43], v[16:31]
  ds_read_b64_tr_b16 v[112:113], v124 offset:30720
  ds_read_b64_tr_b16 v[114:115], v124 offset:31040
  s_waitcnt vmcnt(16) lgkmcnt(4)
  v_mfma_f32_32x32x16_bf16 v[0:15], v[116:119], v[44:47], v[0:15]
  ds_read_b64_tr_b16 v[116:117], v125 offset:30720
  ds_read_b64_tr_b16 v[118:119], v125 offset:31040
  s_waitcnt vmcnt(16) lgkmcnt(4)
  v_mfma_f32_32x32x16_bf16 v[16:31], v[120:123], v[44:47], v[16:31]
  ds_read_b64_tr_b16 v[120:121], v124 offset:32000
  ds_read_b64_tr_b16 v[122:123], v124 offset:32320
  s_waitcnt vmcnt(15) lgkmcnt(4)
  v_mfma_f32_32x32x16_bf16 v[0:15], v[112:115], v[48:51], v[0:15]
  ds_read_b64_tr_b16 v[112:113], v125 offset:32000
  ds_read_b64_tr_b16 v[114:115], v125 offset:32320
  s_waitcnt vmcnt(15) lgkmcnt(4)
  v_mfma_f32_32x32x16_bf16 v[16:31], v[116:119], v[48:51], v[16:31]
  ds_read_b64_tr_b16 v[116:117], v124 offset:33280
  ds_read_b64_tr_b16 v[118:119], v124 offset:33600
  s_waitcnt vmcnt(14) lgkmcnt(4)
  v_mfma_f32_32x32x16_bf16 v[0:15], v[120:123], v[52:55], v[0:15]
  ds_read_b64_tr_b16 v[120:121], v125 offset:33280
  ds_read_b64_tr_b16 v[122:123], v125 offset:33600
  s_waitcnt vmcnt(14) lgkmcnt(4)
  v_mfma_f32_32x32x16_bf16 v[16:31], v[112:115], v[52:55], v[16:31]
  ds_read_b64_tr_b16 v[112:113], v124 offset:34560
  ds_read_b64_tr_b16 v[114:115], v124 offset:34880
  s_waitcnt vmcnt(13) lgkmcnt(4)
  v_mfma_f32_32x32x16_bf16 v[0:15], v[116:119], v[56:59], v[0:15]
  ds_read_b64_tr_b16 v[116:117], v125 offset:34560
  ds_read_b64_tr_b16 v[118:119], v125 offset:34880
  s_waitcnt vmcnt(13) lgkmcnt(4)
  v_mfma_f32_32x32x16_bf16 v[16:31], v[120:123], v[56:59], v[16:31]
  ds_read_b64_tr_b16 v[120:121], v124 offset:35840
  ds_read_b64_tr_b16 v[122:123], v124 offset:36160
  s_waitcnt vmcnt(12) lgkmcnt(4)
  v_mfma_f32_32x32x16_bf16 v[0:15], v[112:115], v[60:63], v[0:15]
  ds_read_b64_tr_b16 v[112:113], v125 offset:35840
  ds_read_b64_tr_b16 v[114:115], v125 offset:36160
  s_waitcnt vmcnt(12) lgkmcnt(4)
  v_mfma_f32_32x32x16_bf16 v[16:31], v[116:119], v[60:63], v[16:31]
  ds_read_b64_tr_b16 v[116:117], v124 offset:37120
  ds_read_b64_tr_b16 v[118:119], v124 offset:37440
  s_waitcnt vmcnt(11) lgkmcnt(4)
  v_mfma_f32_32x32x16_bf16 v[0:15], v[120:123], v[64:67], v[0:15]
  ds_read_b64_tr_b16 v[120:121], v125 offset:37120
  ds_read_b64_tr_b16 v[122:123], v125 offset:37440
  s_waitcnt vmcnt(11) lgkmcnt(4)
  v_mfma_f32_32x32x16_bf16 v[16:31], v[112:115], v[64:67], v[16:31]
  ds_read_b64_tr_b16 v[112:113], v124 offset:38400
  ds_read_b64_tr_b16 v[114:115], v124 offset:38720
  s_waitcnt vmcnt(10) lgkmcnt(4)
  v_mfma_f32_32x32x16_bf16 v[0:15], v[116:119], v[68:71], v[0:15]
  ds_read_b64_tr_b16 v[116:117], v125 offset:38400
  ds_read_b64_tr_b16 v[118:119], v125 offset:38720
  s_waitcnt vmcnt(10) lgkmcnt(4)
  v_mfma_f32_32x32x16_bf16 v[16:31], v[120:123], v[68:71], v[16:31]
  ds_read_b64_tr_b16 v[120:121], v124 offset:39680
  ds_read_b64_tr_b16 v[122:123], v124 offset:40000
  s_waitcnt vmcnt(9) lgkmcnt(4)
  v_mfma_f32_32x32x16_bf16 v[0:15], v[112:115], v[72:75], v[0:15]
  ds_read_b64_tr_b16 v[112:113], v125 offset:39680
  ds_read_b64_tr_b16 v[114:115], v125 offset:40000
  s_waitcnt vmcnt(9) lgkmcnt(4)
  v_mfma_f32_32x32x16_bf16 v[16:31], v[116:119], v[72:75], v[16:31]
  ds_read_b64_tr_b16 v[116:117], v124 offset:40960
  ds_read_b64_tr_b16 v[118:119], v124 offset:41280
  s_waitcnt vmcnt(8) lgkmcnt(4)
  v_mfma_f32_32x32x16_bf16 v[0:15], v[120:123], v[76:79], v[0:15]
  ds_read_b64_tr_b16 v[120:121], v125 offset:40960
  ds_read_b64_tr_b16 v[122:123], v125 offset:41280
  s_waitcnt vmcnt(8) lgkmcnt(4)
  v_mfma_f32_32x32x16_bf16 v[16:31], v[112:115], v[76:79], v[16:31]
  ds_read_b64_tr_b16 v[112:113], v124 offset:42240
  ds_read_b64_tr_b16 v[114:115], v124 offset:42560
  s_waitcnt vmcnt(7) lgkmcnt(4)
  v_mfma_f32_32x32x16_bf16 v[0:15], v[116:119], v[80:83], v[0:15]
  ds_read_b64_tr_b16 v[116:117], v125 offset:42240
  ds_read_b64_tr_b16 v[118:119], v125 offset:42560
  s_waitcnt vmcnt(7) lgkmcnt(4)
  v_mfma_f32_32x32x16_bf16 v[16:31], v[120:123], v[80:83], v[16:31]
  ds_read_b64_tr_b16 v[120:121], v124 offset:43520
  ds_read_b64_tr_b16 v[122:123], v124 offset:43840
  s_waitcnt vmcnt(6) lgkmcnt(4)
  v_mfma_f32_32x32x16_bf16 v[0:15], v[112:115], v[84:87], v[0:15]
  ds_read_b64_tr_b16 v[112:113], v125 offset:43520
  ds_read_b64_tr_b16 v[114:115], v125 offset:43840
  s_waitcnt vmcnt(6) lgkmcnt(4)
  v_mfma_f32_32x32x16_bf16 v[16:31], v[116:119], v[84:87], v[16:31]
  ds_read_b64_tr_b16 v[116:117], v124 offset:44800
  ds_read_b64_tr_b16 v[118:119], v124 offset:45120
  s_waitcnt vmcnt(5) lgkmcnt(4)
  v_mfma_f32_32x32x16_bf16 v[0:15], v[120:123], v[88:91], v[0:15]
  ds_read_b64_tr_b16 v[120:121], v125 offset:44800
  ds_read_b64_tr_b16 v[122:123], v125 offset:45120
  s_waitcnt vmcnt(5) lgkmcnt(4)
  v_mfma_f32_32x32x16_bf16 v[16:31], v[112:115], v[88:91], v[16:31]
  ds_read_b64_tr_b16 v[112:113], v124 offset:46080
  ds_read_b64_tr_b16 v[114:115], v124 offset:46400
  s_waitcnt vmcnt(4) lgkmcnt(4)
  v_mfma_f32_32x32x16_bf16 v[0:15], v[116:119], v[92:95], v[0:15]
  ds_read_b64_tr_b16 v[116:117], v125 offset:46080
  ds_read_b64_tr_b16 v[118:119], v125 offset:46400
  s_waitcnt vmcnt(4) lgkmcnt(4)
  v_mfma_f32_32x32x16_bf16 v[16:31], v[120:123], v[92:95], v[16:31]
  ds_read_b64_tr_b16 v[120:121], v124 offset:47360
  ds_read_b64_tr_b16 v[122:123], v124 offset:47680
  s_waitcnt vmcnt(3) lgkmcnt(4)
  v_mfma_f32_32x32x16_bf16 v[0:15], v[112:115], v[96:99], v[0:15]
  ds_read_b64_tr_b16 v[112:113], v125 offset:47360
  ds_read_b64_tr_b16 v[114:115], v125 offset:47680
  s_waitcnt vmcnt(3) lgkmcnt(4)
  v_mfma_f32_32x32x16_bf16 v[16:31], v[116:119], v[96:99], v[16:31]
  ds_read_b64_tr_b16 v[116:117], v124 offset:48640
  ds_read_b64_tr_b16 v[118:119], v124 offset:48960
  s_waitcnt vmcnt(2) lgkmcnt(4)
  v_mfma_f32_32x32x16_bf16 v[0:15], v[120:123], v[100:103], v[0:15]
  ds_read_b64_tr_b16 v[120:121], v125 offset:48640
  ds_read_b64_tr_b16 v[122:123], v125 offset:48960
  s_waitcnt vmcnt(2) lgkmcnt(4)
  v_mfma_f32_32x32x16_bf16 v[16:31], v[112:115], v[100:103], v[16:31]
  ds_read_b64_tr_b16 v[112:113], v124 offset:49920
  ds_read_b64_tr_b16 v[114:115], v124 offset:50240
  s_waitcnt vmcnt(1) lgkmcnt(4)
  v_mfma_f32_32x32x16_bf16 v[0:15], v[116:119], v[104:107], v[0:15]
  ds_read_b64_tr_b16 v[116:117], v125 offset:49920
  ds_read_b64_tr_b16 v[118:119], v125 offset:50240
  s_waitcnt vmcnt(1) lgkmcnt(4)
  v_mfma_f32_32x32x16_bf16 v[16:31], v[120:123], v[104:107], v[16:31]
  s_waitcnt vmcnt(0) lgkmcnt(2)
  v_mfma_f32_32x32x16_bf16 v[0:15], v[112:115], v[108:111], v[0:15]
  s_waitcnt vmcnt(0) lgkmcnt(0)
  v_mfma_f32_32x32x16_bf16 v[16:31], v[116:119], v[108:111], v[16:31]
  v_and_b32 v60, 31, v127
  v_lshrrev_b32 v61, 5, v127
  v_mul_u32_u24 v60, 2560, v60
  v_mad_u32_u24 v60, v61, 40, v60
  s_mul_i32 s3, s43, 81920
  s_mul_i32 s34, s55, 80
  s_add_u32 s3, s3, s34
  s_add_u32 s3, s3, 1280
  s_nop 1
  v_cvt_pk_bf16_f32 v64, v0, v1
  v_cvt_pk_bf16_f32 v65, v2, v3
  v_cvt_pk_bf16_f32 v66, v4, v5
  v_cvt_pk_bf16_f32 v67, v6, v7
  v_cvt_pk_bf16_f32 v68, v8, v9
  v_cvt_pk_bf16_f32 v69, v10, v11
  v_cvt_pk_bf16_f32 v70, v12, v13
  v_cvt_pk_bf16_f32 v71, v14, v15
  v_cvt_pk_bf16_f32 v72, v16, v17
  v_cvt_pk_bf16_f32 v73, v18, v19
  buffer_store_dwordx4 v[64:67], v60, s[60:63], s3 offen
  buffer_store_dwordx4 v[68:71], v60, s[60:63], s3 offen offset:16
  buffer_store_dwordx2 v[72:73], v60, s[60:63], s3 offen offset:32
k2_end:
  s_endpgm
.section .rodata,"a"
.p2align 6
.amdhsa_kernel concat_heads__mha_block__linear_kernel_hedgehog__prompt_kernel
  .amdhsa_next_free_vgpr 128
  .amdhsa_next_free_sgpr 96
  .amdhsa_accum_offset 128
  .amdhsa_group_segment_fixed_size 0
  .amdhsa_kernarg_size 80
  .amdhsa_user_sgpr_count 2
  .amdhsa_user_sgpr_kernarg_segment_ptr 1
  .amdhsa_system_sgpr_workgroup_id_x 1
.end_amdhsa_kernel
```
